```python
import torch

def _softmax(x, axis=-1):
    return torch.softmax(x, dim=axis)
def _gelu(x):
    return torch.nn.functional.gelu(x, approximate="tanh")
def _silu(x):
    return torch.nn.functional.silu(x)
def _sigmoid(x):
    return torch.sigmoid(x)
def _layernorm(x, axis=-1, eps=1e-5):
    m = x.mean(dim=axis, keepdim=True)
    v = x.var(dim=axis, keepdim=True, unbiased=False)
    return (x - m) / torch.sqrt(v + eps)
def _scatter_add(tgt, idx, src, axis=0):
    return tgt.clone().index_add_(axis, idx, src)
def _segment_sum(src, seg, n):
    out = torch.zeros((n,) + src.shape[1:], dtype=src.dtype)
    return out.index_add_(0, seg, src)
def _pad(x, pw):
    flat = tuple(v for pair in reversed(pw) for v in pair)
    return torch.nn.functional.pad(x, flat)

kernel_name = 'recurrent_scan__spectral_fnet__dense_activation_silu__prompt'

def setup_inputs():

    _w = (lambda a: (lambda t: t.to(torch.bfloat16) if t.is_floating_point() else t)(torch.as_tensor(a)))
    def _A_setup():
        B, S, D = 1, 2048, 640
        ns = torch.arange(S)[:, None] * torch.arange(S)[None, :]
        nd = torch.arange(D)[:, None] * torch.arange(D)[None, :]
        Ws_re = torch.cos(-2.0 * torch.pi * ns / S).to(float)
        Ws_im = torch.sin(-2.0 * torch.pi * ns / S).to(float)
        Wd_re = torch.cos(-2.0 * torch.pi * nd / D).to(float)
        Wd_im = torch.sin(-2.0 * torch.pi * nd / D).to(float)
        return {
            "x": _w((lambda *s: torch.randn(*s, dtype=torch.bfloat16) * 0.05)(B, S, D)),
            "dft_seq_re": _w(Ws_re),
            "dft_seq_im": _w(Ws_im),
            "dft_hid_re": _w(Wd_re),
            "dft_hid_im": _w(Wd_im),
        }
    _A_in = _A_setup()

    def _B_setup():
        B, S, D, F = 1, 2048, 640, 1536
        return {
            "x": _w((lambda *s: torch.randn(*s, dtype=torch.bfloat16) * 0.05)(B, S, D)),
            "w1": _w((lambda *s: torch.randn(*s, dtype=torch.bfloat16) * 0.2)(D, F) * (D ** -0.5)),
            "w2": _w((lambda *s: torch.randn(*s, dtype=torch.bfloat16) * 0.05)(F, D) * (F ** -0.5)),
        }
    _B_in = _B_setup()

    return {
        "A_x": _A_in["x"],
        "A_dft_seq_re": _A_in["dft_seq_re"],
        "A_dft_seq_im": _A_in["dft_seq_im"],
        "A_dft_hid_re": _A_in["dft_hid_re"],
        "A_dft_hid_im": _A_in["dft_hid_im"],
        "B_x": _B_in["x"],
        "B_w1": _B_in["w1"],
        "B_w2": _B_in["w2"],
    }

def reference(A_x, A_dft_seq_re, A_dft_seq_im, A_dft_hid_re, A_dft_hid_im, B_x, B_w1, B_w2):
    def _A_ref(x, dft_seq_re, dft_seq_im, dft_hid_re, dft_hid_im):
        a = torch.einsum("bsd,ed->bse", x, dft_hid_re)
        b = torch.einsum("bsd,ed->bse", x, dft_hid_im)
        y = torch.einsum("ts,bse->bte", dft_seq_re, a) - torch.einsum("ts,bse->bte", dft_seq_im, b)
        return y

    def _B_ref(x, w1, w2):
        h = torch.einsum("bsd,df->bsf", x, w1)
        h = _silu(h)
        out = torch.einsum("bsf,fd->bsd", h, w2)
        return out

    x = A_x
    xn = _layernorm(x, axis=-1)
    s = _A_ref(xn, A_dft_seq_re, A_dft_seq_im, A_dft_hid_re, A_dft_hid_im)
    g = _silu(_B_ref(xn, B_w1, B_w2))
    return x + s * g
```

```asm
; @launch grid=(256,1,1) block=(256,1,1) lds=160768
.amdgcn_target "amdgcn-amd-amdhsa--gfx950"
.text
.globl recurrent_scan__spectral_fnet__dense_activation_silu__prompt_kernel
.p2align 8
.type recurrent_scan__spectral_fnet__dense_activation_silu__prompt_kernel,@function
recurrent_scan__spectral_fnet__dense_activation_silu__prompt_kernel:
s_cmp_ge_u32 s2, 256
s_cbranch_scc1 F_end
s_load_dwordx16 s[36:51], s[0:1], 0
s_load_dwordx2 s[86:87], s[0:1], 80
s_load_dwordx2 s[20:21], s[0:1], 64
v_lshrrev_b32 v1, 6, v0
v_and_b32 v0, 63, v0
v_readfirstlane_b32 s24, v1
s_getpc_b64 s[96:97]
F_pc:
s_lshr_b32 s56, s2, 3
s_lshl_b32 s57, s24, 5
s_add_u32 s56, s56, s57
s_lshl_b32 s56, s56, 10
s_cmp_lt_u32 s56, F_codeend-F_pc-1024
s_cbranch_scc0 F_nopf
v_lshl_add_u32 v5, v0, 4, s56
global_load_dwordx4 v[196:199], v5, s[96:97]
F_nopf:
s_and_b32 s88, s2, 7
s_lshr_b32 s89, s2, 3
s_lshr_b32 s56, s88, 1
s_lshl_b32 s56, s56, 2
s_and_b32 s57, s89, 3
s_add_u32 s25, s56, s57
s_lshr_b32 s58, s89, 2
s_and_b32 s59, s88, 1
s_lshl_b32 s56, s56, 1
s_and_b32 s57, s89, 7
s_add_u32 s90, s56, s57
s_lshl_b32 s56, s59, 2
s_lshr_b32 s57, s89, 3
s_add_u32 s91, s56, s57
v_and_b32 v1, 15, v0
v_lshrrev_b32 v2, 4, v0
v_lshrrev_b32 v3, 3, v0
v_and_b32 v4, 7, v0
s_mov_b32 s6, 2621440
s_mov_b32 s7, 0x00020000
s_mov_b32 s11, 0x00020000
s_mov_b32 s15, 0x00020000
s_mov_b32 s19, 0x00020000
s_mov_b32 s22, 2621440
s_mov_b32 s23, 0x00020000
s_lshl_b32 s60, s25, 2
s_add_u32 s60, s60, s24
s_mul_i32 s61, s60, 1280
s_lshl_b32 s34, s24, 12
s_mul_i32 s94, s91, 245760
s_mul_i32 s56, s24, 61440
s_add_u32 s94, s94, s56
v_mov_b32 v27, 11550720
s_sub_u32 s3, s2, 64
s_cmp_ge_u32 s58, 2
s_cbranch_scc1 K1_g1
K1_dft:
s_lshl_b32 s26, s59, 1
s_add_u32 s26, s26, s58
v_xor_b32 v5, v4, v2
v_lshlrev_b32 v5, 4, v5
v_lshrrev_b32 v6, 2, v3
v_and_b32 v7, 3, v3
v_lshl_add_u32 v6, v6, 3, v7
v_mov_b32 v7, 81920
v_mul_u32_u24 v6, v7, v6
v_add3_u32 v6, v6, v5, s61
v_mov_b32 v8, v6
v_xor_b32 v7, 64, v6
v_add_u32 v9, 1309696, v7
v_add_u32 v10, 325632, v6
v_add_u32 v11, 1635328, v7
s_and_b32 s62, s24, 1
s_lshl_b32 s63, s62, 2
v_add_u32 v5, s63, v2
v_xor_b32 v5, v5, v4
v_lshlrev_b32 v5, 4, v5
s_mul_i32 s63, s26, 80
s_lshl_b32 s62, s62, 3
s_add_u32 s63, s63, s62
v_add_u32 v6, s63, v3
v_mov_b32 v7, 1280
v_mad_u32_u24 v21, v6, v7, v5
v_add_u32 v13, 19456, v21
v_add_u32 v14, 38912, v21
v_add_u32 v15, 58368, v21
v_add_u32 v16, 81920, v21
v_cmp_eq_u32 vcc, 0, v6
v_add_u32 v22, 409600, v21
s_nop 0
v_cndmask_b32 v12, v21, v22, vcc
v_lshlrev_b32 v5, 18, v1
v_lshl_add_u32 v5, v2, 4, v5
v_add_u32 v6, 4194304, v5
s_mov_b32 s28, 0
s_mul_i32 s35, s24, 5120
s_add_u32 s35, s35, 16384
s_waitcnt lgkmcnt(0)
global_load_dword v23, v27, s[86:87] sc1
s_mov_b32 s4, s36
s_mov_b32 s5, s37
s_cmp_ge_u32 s24, 2
s_cselect_b32 s8, s44, s42
s_cselect_b32 s9, s45, s43
s_mov_b32 s10, 819200
s_add_u32 m0, s34, 0
s_nop 0
buffer_load_dwordx4 v8, s[4:7], s28 offen lds
buffer_load_dwordx4 v9, s[4:7], s28 offen offset:1024 lds
buffer_load_dwordx4 v10, s[4:7], s28 offen offset:2048 lds
buffer_load_dwordx4 v11, s[4:7], s28 offen offset:3072 lds
s_add_u32 m0, s35, 0
s_nop 0
buffer_load_dwordx4 v12, s[8:11], s28 offen lds
buffer_load_dwordx4 v13, s[8:11], s28 offen offset:1024 lds
buffer_load_dwordx4 v14, s[8:11], s28 offen offset:2048 lds
buffer_load_dwordx4 v15, s[8:11], s28 offen offset:3072 lds
s_add_u32 m0, m0, 4096
s_nop 0
buffer_load_dwordx4 v16, s[8:11], s28 offen lds
s_add_u32 s28, s28, 128
global_load_dwordx4 v[220:223], v5, s[38:39]
global_load_dwordx4 v[224:227], v6, s[38:39]
global_load_dwordx4 v[228:231], v5, s[40:41]
global_load_dwordx4 v[232:235], v6, s[40:41]
s_add_u32 m0, s34, 36864
s_nop 0
buffer_load_dwordx4 v8, s[4:7], s28 offen lds
v_lshrrev_b32 v7, 1, v1
v_xor_b32 v7, v7, v2
v_lshlrev_b32 v7, 4, v7
v_lshl_add_u32 v21, v1, 7, v7
buffer_load_dwordx4 v9, s[4:7], s28 offen offset:1024 lds
v_add_u32 v17, s34, v21
v_xor_b32 v18, 64, v17
v_lshrrev_b32 v21, 3, v1
v_mul_u32_u24 v21, 5120, v21
buffer_load_dwordx4 v10, s[4:7], s28 offen offset:2048 lds
v_and_b32 v22, 7, v1
v_lshl_add_u32 v21, v22, 7, v21
v_add_u32 v21, v21, v7
v_add_u32 v19, 16384, v21
buffer_load_dwordx4 v11, s[4:7], s28 offen offset:3072 lds
v_xor_b32 v20, 64, v19
v_mov_b32 v120, 0x3f803f80
v_mov_b32 v121, 0x3f803f80
v_mov_b32 v122, 0x3f803f80
s_add_u32 m0, s35, 36864
s_nop 0
buffer_load_dwordx4 v12, s[8:11], s28 offen lds
v_mov_b32 v123, 0x3f803f80
v_and_b32 v236, 3, v0
v_cmp_eq_u32 s[50:51], 1, v236
v_cmp_eq_u32 s[52:53], 2, v236
buffer_load_dwordx4 v13, s[8:11], s28 offen offset:1024 lds
v_cmp_eq_u32 s[54:55], 3, v236
v_and_b32 v236, 15, v0
v_lshrrev_b32 v247, 2, v236
v_lshlrev_b32 v247, 6, v247
buffer_load_dwordx4 v14, s[8:11], s28 offen offset:2048 lds
v_lshl_add_u32 v247, v236, 2, v247
v_lshlrev_b32 v254, 4, v0
s_lshr_b32 s62, s91, 1
s_lshl_b32 s62, s62, 9
buffer_load_dwordx4 v15, s[8:11], s28 offen offset:3072 lds
s_add_u32 s62, s62, 11542528
v_lshl_add_u32 v253, v0, 4, s62
s_add_u32 m0, m0, 4096
s_nop 0
buffer_load_dwordx4 v16, s[8:11], s28 offen lds
s_add_u32 s28, s28, 128
s_add_u32 s56, s58, 6
s_lshl_b32 s56, s56, 2
s_add_u32 s56, s56, s24
s_lshl_b32 s56, s56, 6
s_lshl_b32 s57, s25, 2
s_add_u32 s56, s56, s57
s_mul_i32 s56, s56, 1280
v_min_u32 v5, 9, v1
v_max_u32 v5, 3, v5
v_lshlrev_b32 v5, 7, v5
s_movk_i32 s57, 1280
v_mad_u32_u24 v5, v2, s57, v5
buffer_load_dword v22, v5, s[4:7], s56 offen
s_and_b32 s56, s25, 3
s_mul_i32 s56, s56, 20
s_mul_i32 s57, s26, 80
s_add_u32 s56, s56, s57
s_and_b32 s57, s24, 1
s_mul_i32 s57, s57, 10
s_add_u32 s56, s56, s57
s_mul_i32 s56, s56, 1280
buffer_load_dword v22, v5, s[8:11], s56 offen
s_add_u32 s56, s56, 5120
buffer_load_dword v22, v5, s[8:11], s56 offen
s_add_u32 s56, s56, 2560
buffer_load_dword v22, v5, s[8:11], s56 offen
s_waitcnt vmcnt(17)
s_nop 0
v_readfirstlane_b32 s65, v23
s_nop 3
s_mul_i32 s65, s65, 0x9E3779B1
s_add_u32 s65, s65, 0x7F4A7C15
s_mov_b32 s16, s86
s_mov_b32 s17, s87
s_add_u32 s16, s16, 9437184
s_addc_u32 s17, s17, 0
s_mov_b32 s18, 1966080
s_barrier
ds_read_b128 v[124:127], v17 offset:0
ds_read_b128 v[128:131], v17 offset:2048
ds_read_b128 v[132:135], v19 offset:0
ds_read_b128 v[152:155], v19 offset:10240
ds_read_b128 v[136:139], v19 offset:1024
ds_read_b128 v[156:159], v19 offset:11264
ds_read_b128 v[140:143], v19 offset:2048
ds_read_b128 v[160:163], v19 offset:12288
ds_read_b128 v[144:147], v19 offset:3072
ds_read_b128 v[164:167], v19 offset:13312
ds_read_b128 v[148:151], v19 offset:4096
ds_read_b128 v[168:171], v19 offset:14336
s_waitcnt lgkmcnt(0)
v_mfma_f32_16x16x32_bf16 v[24:27], v[124:127], v[132:135], 0
ds_read_b128 v[172:175], v18 offset:0
v_mfma_f32_16x16x32_bf16 v[28:31], v[128:131], v[132:135], 0
ds_read_b128 v[176:179], v18 offset:2048
s_add_u32 m0, s34, 73728
s_nop 0
buffer_load_dwordx4 v8, s[4:7], s28 offen lds
v_mfma_f32_16x16x32_bf16 v[32:35], v[124:127], v[152:155], 0
ds_read_b128 v[180:183], v20 offset:0
v_mfma_f32_16x16x32_bf16 v[36:39], v[128:131], v[152:155], 0
ds_read_b128 v[200:203], v20 offset:10240
buffer_load_dwordx4 v9, s[4:7], s28 offen offset:1024 lds
v_mfma_f32_16x16x32_bf16 v[104:107], v[120:123], v[124:127], 0
ds_read_b128 v[184:187], v20 offset:1024
v_mfma_f32_16x16x32_bf16 v[40:43], v[124:127], v[136:139], 0
ds_read_b128 v[204:207], v20 offset:11264
buffer_load_dwordx4 v10, s[4:7], s28 offen offset:2048 lds
v_mfma_f32_16x16x32_bf16 v[44:47], v[128:131], v[136:139], 0
ds_read_b128 v[188:191], v20 offset:2048
v_mfma_f32_16x16x32_bf16 v[48:51], v[124:127], v[156:159], 0
ds_read_b128 v[208:211], v20 offset:12288
v_mfma_f32_16x16x32_bf16 v[52:55], v[128:131], v[156:159], 0
ds_read_b128 v[192:195], v20 offset:3072
buffer_load_dwordx4 v11, s[4:7], s28 offen offset:3072 lds
v_mfma_f32_16x16x32_bf16 v[108:111], v[120:123], v[128:131], 0
ds_read_b128 v[212:215], v20 offset:13312
v_mfma_f32_16x16x32_bf16 v[56:59], v[124:127], v[140:143], 0
ds_read_b128 v[196:199], v20 offset:4096
s_add_u32 m0, s35, 73728
s_nop 0
buffer_load_dwordx4 v12, s[8:11], s28 offen lds
v_mfma_f32_16x16x32_bf16 v[60:63], v[128:131], v[140:143], 0
ds_read_b128 v[216:219], v20 offset:14336
v_mfma_f32_16x16x32_bf16 v[64:67], v[124:127], v[160:163], 0
v_add_u32 v17, 36864, v17
v_add_u32 v18, 36864, v18
v_add_u32 v19, 36864, v19
buffer_load_dwordx4 v13, s[8:11], s28 offen offset:1024 lds
v_mfma_f32_16x16x32_bf16 v[68:71], v[128:131], v[160:163], 0
v_add_u32 v20, 36864, v20
v_mfma_f32_16x16x32_bf16 v[112:115], v[124:127], v[124:127], 0
v_mfma_f32_16x16x32_bf16 v[72:75], v[124:127], v[144:147], 0
buffer_load_dwordx4 v14, s[8:11], s28 offen offset:2048 lds
v_mfma_f32_16x16x32_bf16 v[76:79], v[128:131], v[144:147], 0
v_mfma_f32_16x16x32_bf16 v[80:83], v[124:127], v[164:167], 0
buffer_load_dwordx4 v15, s[8:11], s28 offen offset:3072 lds
v_mfma_f32_16x16x32_bf16 v[84:87], v[128:131], v[164:167], 0
v_mfma_f32_16x16x32_bf16 v[116:119], v[128:131], v[128:131], 0
s_add_u32 m0, m0, 4096
s_nop 0
buffer_load_dwordx4 v16, s[8:11], s28 offen lds
s_add_u32 s28, s28, 128
v_mfma_f32_16x16x32_bf16 v[88:91], v[124:127], v[148:151], 0
v_mfma_f32_16x16x32_bf16 v[92:95], v[128:131], v[148:151], 0
v_mfma_f32_16x16x32_bf16 v[96:99], v[124:127], v[168:171], 0
v_mfma_f32_16x16x32_bf16 v[100:103], v[128:131], v[168:171], 0
s_waitcnt vmcnt(13) lgkmcnt(0)
s_barrier
v_mfma_f32_16x16x32_bf16 v[24:27], v[172:175], v[180:183], v[24:27]
ds_read_b128 v[124:127], v17 offset:0
v_mfma_f32_16x16x32_bf16 v[28:31], v[176:179], v[180:183], v[28:31]
ds_read_b128 v[128:131], v17 offset:2048
s_add_u32 m0, s34, 110592
s_nop 0
buffer_load_dwordx4 v8, s[4:7], s28 offen lds
v_mfma_f32_16x16x32_bf16 v[32:35], v[172:175], v[200:203], v[32:35]
ds_read_b128 v[132:135], v19 offset:0
v_mfma_f32_16x16x32_bf16 v[36:39], v[176:179], v[200:203], v[36:39]
ds_read_b128 v[152:155], v19 offset:10240
buffer_load_dwordx4 v9, s[4:7], s28 offen offset:1024 lds
v_mfma_f32_16x16x32_bf16 v[104:107], v[120:123], v[172:175], v[104:107]
ds_read_b128 v[136:139], v19 offset:1024
v_mfma_f32_16x16x32_bf16 v[40:43], v[172:175], v[184:187], v[40:43]
ds_read_b128 v[156:159], v19 offset:11264
buffer_load_dwordx4 v10, s[4:7], s28 offen offset:2048 lds
v_mfma_f32_16x16x32_bf16 v[44:47], v[176:179], v[184:187], v[44:47]
ds_read_b128 v[140:143], v19 offset:2048
v_mfma_f32_16x16x32_bf16 v[48:51], v[172:175], v[204:207], v[48:51]
ds_read_b128 v[160:163], v19 offset:12288
v_mfma_f32_16x16x32_bf16 v[52:55], v[176:179], v[204:207], v[52:55]
ds_read_b128 v[144:147], v19 offset:3072
buffer_load_dwordx4 v11, s[4:7], s28 offen offset:3072 lds
v_mfma_f32_16x16x32_bf16 v[108:111], v[120:123], v[176:179], v[108:111]
ds_read_b128 v[164:167], v19 offset:13312
v_mfma_f32_16x16x32_bf16 v[56:59], v[172:175], v[188:191], v[56:59]
ds_read_b128 v[148:151], v19 offset:4096
s_add_u32 m0, s35, 110592
s_nop 0
buffer_load_dwordx4 v12, s[8:11], s28 offen lds
v_mfma_f32_16x16x32_bf16 v[60:63], v[176:179], v[188:191], v[60:63]
ds_read_b128 v[168:171], v19 offset:14336
v_mfma_f32_16x16x32_bf16 v[64:67], v[172:175], v[208:211], v[64:67]
buffer_load_dwordx4 v13, s[8:11], s28 offen offset:1024 lds
v_mfma_f32_16x16x32_bf16 v[68:71], v[176:179], v[208:211], v[68:71]
v_mfma_f32_16x16x32_bf16 v[112:115], v[172:175], v[172:175], v[112:115]
v_mfma_f32_16x16x32_bf16 v[72:75], v[172:175], v[192:195], v[72:75]
buffer_load_dwordx4 v14, s[8:11], s28 offen offset:2048 lds
v_mfma_f32_16x16x32_bf16 v[76:79], v[176:179], v[192:195], v[76:79]
v_mfma_f32_16x16x32_bf16 v[80:83], v[172:175], v[212:215], v[80:83]
buffer_load_dwordx4 v15, s[8:11], s28 offen offset:3072 lds
v_mfma_f32_16x16x32_bf16 v[84:87], v[176:179], v[212:215], v[84:87]
v_mfma_f32_16x16x32_bf16 v[116:119], v[176:179], v[176:179], v[116:119]
s_add_u32 m0, m0, 4096
s_nop 0
buffer_load_dwordx4 v16, s[8:11], s28 offen lds
s_add_u32 s28, s28, 128
v_mfma_f32_16x16x32_bf16 v[88:91], v[172:175], v[196:199], v[88:91]
v_mfma_f32_16x16x32_bf16 v[92:95], v[176:179], v[196:199], v[92:95]
v_mfma_f32_16x16x32_bf16 v[96:99], v[172:175], v[216:219], v[96:99]
v_mfma_f32_16x16x32_bf16 v[100:103], v[176:179], v[216:219], v[100:103]
s_waitcnt lgkmcnt(0)
v_mfma_f32_16x16x32_bf16 v[24:27], v[124:127], v[132:135], v[24:27]
ds_read_b128 v[172:175], v18 offset:0
v_mfma_f32_16x16x32_bf16 v[28:31], v[128:131], v[132:135], v[28:31]
ds_read_b128 v[176:179], v18 offset:2048
s_add_u32 m0, s34, 0
s_nop 0
buffer_load_dwordx4 v8, s[4:7], s28 offen lds
v_mfma_f32_16x16x32_bf16 v[32:35], v[124:127], v[152:155], v[32:35]
ds_read_b128 v[180:183], v20 offset:0
v_mfma_f32_16x16x32_bf16 v[36:39], v[128:131], v[152:155], v[36:39]
ds_read_b128 v[200:203], v20 offset:10240
buffer_load_dwordx4 v9, s[4:7], s28 offen offset:1024 lds
v_mfma_f32_16x16x32_bf16 v[104:107], v[120:123], v[124:127], v[104:107]
ds_read_b128 v[184:187], v20 offset:1024
v_mfma_f32_16x16x32_bf16 v[40:43], v[124:127], v[136:139], v[40:43]
ds_read_b128 v[204:207], v20 offset:11264
buffer_load_dwordx4 v10, s[4:7], s28 offen offset:2048 lds
v_mfma_f32_16x16x32_bf16 v[44:47], v[128:131], v[136:139], v[44:47]
ds_read_b128 v[188:191], v20 offset:2048
v_mfma_f32_16x16x32_bf16 v[48:51], v[124:127], v[156:159], v[48:51]
ds_read_b128 v[208:211], v20 offset:12288
v_mfma_f32_16x16x32_bf16 v[52:55], v[128:131], v[156:159], v[52:55]
ds_read_b128 v[192:195], v20 offset:3072
buffer_load_dwordx4 v11, s[4:7], s28 offen offset:3072 lds
v_mfma_f32_16x16x32_bf16 v[108:111], v[120:123], v[128:131], v[108:111]
ds_read_b128 v[212:215], v20 offset:13312
v_mfma_f32_16x16x32_bf16 v[56:59], v[124:127], v[140:143], v[56:59]
ds_read_b128 v[196:199], v20 offset:4096
s_add_u32 m0, s35, 0
s_nop 0
buffer_load_dwordx4 v12, s[8:11], s28 offen lds
v_mfma_f32_16x16x32_bf16 v[60:63], v[128:131], v[140:143], v[60:63]
ds_read_b128 v[216:219], v20 offset:14336
v_mfma_f32_16x16x32_bf16 v[64:67], v[124:127], v[160:163], v[64:67]
v_add_u32 v17, 36864, v17
v_add_u32 v18, 36864, v18
v_add_u32 v19, 36864, v19
buffer_load_dwordx4 v13, s[8:11], s28 offen offset:1024 lds
v_mfma_f32_16x16x32_bf16 v[68:71], v[128:131], v[160:163], v[68:71]
v_add_u32 v20, 36864, v20
v_mfma_f32_16x16x32_bf16 v[112:115], v[124:127], v[124:127], v[112:115]
v_mfma_f32_16x16x32_bf16 v[72:75], v[124:127], v[144:147], v[72:75]
buffer_load_dwordx4 v14, s[8:11], s28 offen offset:2048 lds
v_mfma_f32_16x16x32_bf16 v[76:79], v[128:131], v[144:147], v[76:79]
v_mfma_f32_16x16x32_bf16 v[80:83], v[124:127], v[164:167], v[80:83]
buffer_load_dwordx4 v15, s[8:11], s28 offen offset:3072 lds
v_mfma_f32_16x16x32_bf16 v[84:87], v[128:131], v[164:167], v[84:87]
v_mfma_f32_16x16x32_bf16 v[116:119], v[128:131], v[128:131], v[116:119]
s_add_u32 m0, m0, 4096
s_nop 0
buffer_load_dwordx4 v16, s[8:11], s28 offen lds
s_add_u32 s28, s28, 128
v_mfma_f32_16x16x32_bf16 v[88:91], v[124:127], v[148:151], v[88:91]
v_mfma_f32_16x16x32_bf16 v[92:95], v[128:131], v[148:151], v[92:95]
v_mfma_f32_16x16x32_bf16 v[96:99], v[124:127], v[168:171], v[96:99]
v_mfma_f32_16x16x32_bf16 v[100:103], v[128:131], v[168:171], v[100:103]
s_waitcnt vmcnt(18) lgkmcnt(0)
s_barrier
v_mfma_f32_16x16x32_bf16 v[24:27], v[172:175], v[180:183], v[24:27]
ds_read_b128 v[124:127], v17 offset:0
v_mfma_f32_16x16x32_bf16 v[28:31], v[176:179], v[180:183], v[28:31]
ds_read_b128 v[128:131], v17 offset:2048
s_add_u32 m0, s34, 36864
s_nop 0
buffer_load_dwordx4 v8, s[4:7], s28 offen lds
v_mfma_f32_16x16x32_bf16 v[32:35], v[172:175], v[200:203], v[32:35]
ds_read_b128 v[132:135], v19 offset:0
v_mfma_f32_16x16x32_bf16 v[36:39], v[176:179], v[200:203], v[36:39]
ds_read_b128 v[152:155], v19 offset:10240
buffer_load_dwordx4 v9, s[4:7], s28 offen offset:1024 lds
v_mfma_f32_16x16x32_bf16 v[104:107], v[120:123], v[172:175], v[104:107]
ds_read_b128 v[136:139], v19 offset:1024
v_mfma_f32_16x16x32_bf16 v[40:43], v[172:175], v[184:187], v[40:43]
ds_read_b128 v[156:159], v19 offset:11264
buffer_load_dwordx4 v10, s[4:7], s28 offen offset:2048 lds
v_mfma_f32_16x16x32_bf16 v[44:47], v[176:179], v[184:187], v[44:47]
ds_read_b128 v[140:143], v19 offset:2048
v_mfma_f32_16x16x32_bf16 v[48:51], v[172:175], v[204:207], v[48:51]
ds_read_b128 v[160:163], v19 offset:12288
v_mfma_f32_16x16x32_bf16 v[52:55], v[176:179], v[204:207], v[52:55]
ds_read_b128 v[144:147], v19 offset:3072
buffer_load_dwordx4 v11, s[4:7], s28 offen offset:3072 lds
v_mfma_f32_16x16x32_bf16 v[108:111], v[120:123], v[176:179], v[108:111]
ds_read_b128 v[164:167], v19 offset:13312
v_mfma_f32_16x16x32_bf16 v[56:59], v[172:175], v[188:191], v[56:59]
ds_read_b128 v[148:151], v19 offset:4096
s_add_u32 m0, s35, 36864
s_nop 0
buffer_load_dwordx4 v12, s[8:11], s28 offen lds
v_mfma_f32_16x16x32_bf16 v[60:63], v[176:179], v[188:191], v[60:63]
ds_read_b128 v[168:171], v19 offset:14336
v_mfma_f32_16x16x32_bf16 v[64:67], v[172:175], v[208:211], v[64:67]
buffer_load_dwordx4 v13, s[8:11], s28 offen offset:1024 lds
v_mfma_f32_16x16x32_bf16 v[68:71], v[176:179], v[208:211], v[68:71]
v_mfma_f32_16x16x32_bf16 v[112:115], v[172:175], v[172:175], v[112:115]
v_mfma_f32_16x16x32_bf16 v[72:75], v[172:175], v[192:195], v[72:75]
buffer_load_dwordx4 v14, s[8:11], s28 offen offset:2048 lds
v_mfma_f32_16x16x32_bf16 v[76:79], v[176:179], v[192:195], v[76:79]
v_mfma_f32_16x16x32_bf16 v[80:83], v[172:175], v[212:215], v[80:83]
buffer_load_dwordx4 v15, s[8:11], s28 offen offset:3072 lds
v_mfma_f32_16x16x32_bf16 v[84:87], v[176:179], v[212:215], v[84:87]
v_mfma_f32_16x16x32_bf16 v[116:119], v[176:179], v[176:179], v[116:119]
s_add_u32 m0, m0, 4096
s_nop 0
buffer_load_dwordx4 v16, s[8:11], s28 offen lds
s_add_u32 s28, s28, 128
v_mfma_f32_16x16x32_bf16 v[88:91], v[172:175], v[196:199], v[88:91]
v_mfma_f32_16x16x32_bf16 v[92:95], v[176:179], v[196:199], v[92:95]
v_mfma_f32_16x16x32_bf16 v[96:99], v[172:175], v[216:219], v[96:99]
v_mfma_f32_16x16x32_bf16 v[100:103], v[176:179], v[216:219], v[100:103]
s_waitcnt lgkmcnt(0)
s_mov_b32 s27, 2
s_mov_b32 s64, 36864
.p2align 5
DF_loop:
v_mfma_f32_16x16x32_bf16 v[24:27], v[124:127], v[132:135], v[24:27]
ds_read_b128 v[172:175], v18 offset:0
s_and_b32 s33, s27, 3
v_mfma_f32_16x16x32_bf16 v[28:31], v[128:131], v[132:135], v[28:31]
ds_read_b128 v[176:179], v18 offset:2048
s_mul_i32 s30, s33, 36864
v_mfma_f32_16x16x32_bf16 v[32:35], v[124:127], v[152:155], v[32:35]
ds_read_b128 v[180:183], v20 offset:0
s_cmp_eq_u32 s33, 3
v_mfma_f32_16x16x32_bf16 v[36:39], v[128:131], v[152:155], v[36:39]
ds_read_b128 v[200:203], v20 offset:10240
s_cselect_b32 s32, -110592, s64
v_mfma_f32_16x16x32_bf16 v[104:107], v[120:123], v[124:127], v[104:107]
ds_read_b128 v[184:187], v20 offset:1024
v_mfma_f32_16x16x32_bf16 v[40:43], v[124:127], v[136:139], v[40:43]
ds_read_b128 v[204:207], v20 offset:11264
v_mfma_f32_16x16x32_bf16 v[44:47], v[128:131], v[136:139], v[44:47]
ds_read_b128 v[188:191], v20 offset:2048
v_mfma_f32_16x16x32_bf16 v[48:51], v[124:127], v[156:159], v[48:51]
ds_read_b128 v[208:211], v20 offset:12288
v_mfma_f32_16x16x32_bf16 v[52:55], v[128:131], v[156:159], v[52:55]
ds_read_b128 v[192:195], v20 offset:3072
v_mfma_f32_16x16x32_bf16 v[108:111], v[120:123], v[128:131], v[108:111]
ds_read_b128 v[212:215], v20 offset:13312
v_mfma_f32_16x16x32_bf16 v[56:59], v[124:127], v[140:143], v[56:59]
ds_read_b128 v[196:199], v20 offset:4096
v_mfma_f32_16x16x32_bf16 v[60:63], v[128:131], v[140:143], v[60:63]
ds_read_b128 v[216:219], v20 offset:14336
v_mfma_f32_16x16x32_bf16 v[64:67], v[124:127], v[160:163], v[64:67]
v_add_u32 v17, s32, v17
v_add_u32 v18, s32, v18
v_add_u32 v19, s32, v19
v_mfma_f32_16x16x32_bf16 v[68:71], v[128:131], v[160:163], v[68:71]
v_add_u32 v20, s32, v20
v_mfma_f32_16x16x32_bf16 v[112:115], v[124:127], v[124:127], v[112:115]
v_mfma_f32_16x16x32_bf16 v[72:75], v[124:127], v[144:147], v[72:75]
v_mfma_f32_16x16x32_bf16 v[76:79], v[128:131], v[144:147], v[76:79]
v_mfma_f32_16x16x32_bf16 v[80:83], v[124:127], v[164:167], v[80:83]
v_mfma_f32_16x16x32_bf16 v[84:87], v[128:131], v[164:167], v[84:87]
v_mfma_f32_16x16x32_bf16 v[116:119], v[128:131], v[128:131], v[116:119]
v_mfma_f32_16x16x32_bf16 v[88:91], v[124:127], v[148:151], v[88:91]
v_mfma_f32_16x16x32_bf16 v[92:95], v[128:131], v[148:151], v[92:95]
v_mfma_f32_16x16x32_bf16 v[96:99], v[124:127], v[168:171], v[96:99]
v_mfma_f32_16x16x32_bf16 v[100:103], v[128:131], v[168:171], v[100:103]
s_waitcnt vmcnt(18) lgkmcnt(0)
s_barrier
v_mfma_f32_16x16x32_bf16 v[24:27], v[172:175], v[180:183], v[24:27]
ds_read_b128 v[124:127], v17 offset:0
v_mfma_f32_16x16x32_bf16 v[28:31], v[176:179], v[180:183], v[28:31]
ds_read_b128 v[128:131], v17 offset:2048
s_add_u32 m0, s30, s34
s_nop 0
buffer_load_dwordx4 v8, s[4:7], s28 offen lds
v_mfma_f32_16x16x32_bf16 v[32:35], v[172:175], v[200:203], v[32:35]
ds_read_b128 v[132:135], v19 offset:0
v_mfma_f32_16x16x32_bf16 v[36:39], v[176:179], v[200:203], v[36:39]
ds_read_b128 v[152:155], v19 offset:10240
buffer_load_dwordx4 v9, s[4:7], s28 offen offset:1024 lds
v_mfma_f32_16x16x32_bf16 v[104:107], v[120:123], v[172:175], v[104:107]
ds_read_b128 v[136:139], v19 offset:1024
v_mfma_f32_16x16x32_bf16 v[40:43], v[172:175], v[184:187], v[40:43]
ds_read_b128 v[156:159], v19 offset:11264
buffer_load_dwordx4 v10, s[4:7], s28 offen offset:2048 lds
v_mfma_f32_16x16x32_bf16 v[44:47], v[176:179], v[184:187], v[44:47]
ds_read_b128 v[140:143], v19 offset:2048
v_mfma_f32_16x16x32_bf16 v[48:51], v[172:175], v[204:207], v[48:51]
ds_read_b128 v[160:163], v19 offset:12288
v_mfma_f32_16x16x32_bf16 v[52:55], v[176:179], v[204:207], v[52:55]
ds_read_b128 v[144:147], v19 offset:3072
buffer_load_dwordx4 v11, s[4:7], s28 offen offset:3072 lds
v_mfma_f32_16x16x32_bf16 v[108:111], v[120:123], v[176:179], v[108:111]
ds_read_b128 v[164:167], v19 offset:13312
v_mfma_f32_16x16x32_bf16 v[56:59], v[172:175], v[188:191], v[56:59]
ds_read_b128 v[148:151], v19 offset:4096
s_add_u32 m0, s30, s35
s_nop 0
buffer_load_dwordx4 v12, s[8:11], s28 offen lds
v_mfma_f32_16x16x32_bf16 v[60:63], v[176:179], v[188:191], v[60:63]
ds_read_b128 v[168:171], v19 offset:14336
v_mfma_f32_16x16x32_bf16 v[64:67], v[172:175], v[208:211], v[64:67]
buffer_load_dwordx4 v13, s[8:11], s28 offen offset:1024 lds
v_mfma_f32_16x16x32_bf16 v[68:71], v[176:179], v[208:211], v[68:71]
v_mfma_f32_16x16x32_bf16 v[112:115], v[172:175], v[172:175], v[112:115]
v_mfma_f32_16x16x32_bf16 v[72:75], v[172:175], v[192:195], v[72:75]
buffer_load_dwordx4 v14, s[8:11], s28 offen offset:2048 lds
v_mfma_f32_16x16x32_bf16 v[76:79], v[176:179], v[192:195], v[76:79]
v_mfma_f32_16x16x32_bf16 v[80:83], v[172:175], v[212:215], v[80:83]
buffer_load_dwordx4 v15, s[8:11], s28 offen offset:3072 lds
v_mfma_f32_16x16x32_bf16 v[84:87], v[176:179], v[212:215], v[84:87]
v_mfma_f32_16x16x32_bf16 v[116:119], v[176:179], v[176:179], v[116:119]
s_add_u32 m0, m0, 4096
s_nop 0
buffer_load_dwordx4 v16, s[8:11], s28 offen lds
v_mfma_f32_16x16x32_bf16 v[88:91], v[172:175], v[196:199], v[88:91]
v_mfma_f32_16x16x32_bf16 v[92:95], v[176:179], v[196:199], v[92:95]
v_mfma_f32_16x16x32_bf16 v[96:99], v[172:175], v[216:219], v[96:99]
s_add_u32 s28, s28, 128
s_add_u32 s27, s27, 1
v_mfma_f32_16x16x32_bf16 v[100:103], v[176:179], v[216:219], v[100:103]
s_cmp_lt_u32 s27, 6
s_waitcnt lgkmcnt(0)
s_cbranch_scc1 DF_loop
v_mfma_f32_16x16x32_bf16 v[24:27], v[124:127], v[132:135], v[24:27]
ds_read_b128 v[172:175], v18 offset:0
v_mfma_f32_16x16x32_bf16 v[28:31], v[128:131], v[132:135], v[28:31]
ds_read_b128 v[176:179], v18 offset:2048
v_mfma_f32_16x16x32_bf16 v[32:35], v[124:127], v[152:155], v[32:35]
ds_read_b128 v[180:183], v20 offset:0
v_mfma_f32_16x16x32_bf16 v[36:39], v[128:131], v[152:155], v[36:39]
ds_read_b128 v[200:203], v20 offset:10240
v_mfma_f32_16x16x32_bf16 v[104:107], v[120:123], v[124:127], v[104:107]
ds_read_b128 v[184:187], v20 offset:1024
v_mfma_f32_16x16x32_bf16 v[40:43], v[124:127], v[136:139], v[40:43]
ds_read_b128 v[204:207], v20 offset:11264
v_mfma_f32_16x16x32_bf16 v[44:47], v[128:131], v[136:139], v[44:47]
ds_read_b128 v[188:191], v20 offset:2048
v_mfma_f32_16x16x32_bf16 v[48:51], v[124:127], v[156:159], v[48:51]
ds_read_b128 v[208:211], v20 offset:12288
v_mfma_f32_16x16x32_bf16 v[52:55], v[128:131], v[156:159], v[52:55]
ds_read_b128 v[192:195], v20 offset:3072
v_mfma_f32_16x16x32_bf16 v[108:111], v[120:123], v[128:131], v[108:111]
ds_read_b128 v[212:215], v20 offset:13312
v_mfma_f32_16x16x32_bf16 v[56:59], v[124:127], v[140:143], v[56:59]
ds_read_b128 v[196:199], v20 offset:4096
v_mfma_f32_16x16x32_bf16 v[60:63], v[128:131], v[140:143], v[60:63]
ds_read_b128 v[216:219], v20 offset:14336
v_mfma_f32_16x16x32_bf16 v[64:67], v[124:127], v[160:163], v[64:67]
v_add_u32 v17, 36864, v17
v_add_u32 v18, 36864, v18
v_add_u32 v19, 36864, v19
v_mfma_f32_16x16x32_bf16 v[68:71], v[128:131], v[160:163], v[68:71]
v_add_u32 v20, 36864, v20
v_mfma_f32_16x16x32_bf16 v[112:115], v[124:127], v[124:127], v[112:115]
v_mfma_f32_16x16x32_bf16 v[72:75], v[124:127], v[144:147], v[72:75]
v_mfma_f32_16x16x32_bf16 v[76:79], v[128:131], v[144:147], v[76:79]
v_mfma_f32_16x16x32_bf16 v[80:83], v[124:127], v[164:167], v[80:83]
v_mfma_f32_16x16x32_bf16 v[84:87], v[128:131], v[164:167], v[84:87]
v_mfma_f32_16x16x32_bf16 v[116:119], v[128:131], v[128:131], v[116:119]
v_mfma_f32_16x16x32_bf16 v[88:91], v[124:127], v[148:151], v[88:91]
v_mfma_f32_16x16x32_bf16 v[92:95], v[128:131], v[148:151], v[92:95]
v_mfma_f32_16x16x32_bf16 v[96:99], v[124:127], v[168:171], v[96:99]
v_mfma_f32_16x16x32_bf16 v[100:103], v[128:131], v[168:171], v[100:103]
s_waitcnt vmcnt(18) lgkmcnt(0)
s_barrier
v_mfma_f32_16x16x32_bf16 v[24:27], v[172:175], v[180:183], v[24:27]
ds_read_b128 v[124:127], v17 offset:0
v_mfma_f32_16x16x32_bf16 v[28:31], v[176:179], v[180:183], v[28:31]
ds_read_b128 v[128:131], v17 offset:2048
s_mov_b64 exec, 0x3fffffff
global_load_dword v252, v253, s[86:87] sc1
s_mov_b64 exec, -1
v_mfma_f32_16x16x32_bf16 v[32:35], v[172:175], v[200:203], v[32:35]
ds_read_b128 v[132:135], v19 offset:0
v_mfma_f32_16x16x32_bf16 v[36:39], v[176:179], v[200:203], v[36:39]
ds_read_b128 v[152:155], v19 offset:10240
v_mfma_f32_16x16x32_bf16 v[104:107], v[120:123], v[172:175], v[104:107]
ds_read_b128 v[136:139], v19 offset:1024
v_mfma_f32_16x16x32_bf16 v[40:43], v[172:175], v[184:187], v[40:43]
ds_read_b128 v[156:159], v19 offset:11264
v_mfma_f32_16x16x32_bf16 v[44:47], v[176:179], v[184:187], v[44:47]
ds_read_b128 v[140:143], v19 offset:2048
v_mfma_f32_16x16x32_bf16 v[48:51], v[172:175], v[204:207], v[48:51]
ds_read_b128 v[160:163], v19 offset:12288
v_mfma_f32_16x16x32_bf16 v[52:55], v[176:179], v[204:207], v[52:55]
ds_read_b128 v[144:147], v19 offset:3072
v_mfma_f32_16x16x32_bf16 v[108:111], v[120:123], v[176:179], v[108:111]
ds_read_b128 v[164:167], v19 offset:13312
v_mfma_f32_16x16x32_bf16 v[56:59], v[172:175], v[188:191], v[56:59]
ds_read_b128 v[148:151], v19 offset:4096
v_mfma_f32_16x16x32_bf16 v[60:63], v[176:179], v[188:191], v[60:63]
ds_read_b128 v[168:171], v19 offset:14336
v_mfma_f32_16x16x32_bf16 v[64:67], v[172:175], v[208:211], v[64:67]
v_mfma_f32_16x16x32_bf16 v[68:71], v[176:179], v[208:211], v[68:71]
v_mfma_f32_16x16x32_bf16 v[112:115], v[172:175], v[172:175], v[112:115]
v_mfma_f32_16x16x32_bf16 v[72:75], v[172:175], v[192:195], v[72:75]
v_mfma_f32_16x16x32_bf16 v[76:79], v[176:179], v[192:195], v[76:79]
v_mfma_f32_16x16x32_bf16 v[80:83], v[172:175], v[212:215], v[80:83]
v_mfma_f32_16x16x32_bf16 v[84:87], v[176:179], v[212:215], v[84:87]
v_mfma_f32_16x16x32_bf16 v[116:119], v[176:179], v[176:179], v[116:119]
v_mfma_f32_16x16x32_bf16 v[88:91], v[172:175], v[196:199], v[88:91]
v_mfma_f32_16x16x32_bf16 v[92:95], v[176:179], v[196:199], v[92:95]
v_mfma_f32_16x16x32_bf16 v[96:99], v[172:175], v[216:219], v[96:99]
v_mfma_f32_16x16x32_bf16 v[100:103], v[176:179], v[216:219], v[100:103]
s_waitcnt lgkmcnt(0)
v_mfma_f32_16x16x32_bf16 v[24:27], v[124:127], v[132:135], v[24:27]
ds_read_b128 v[172:175], v18 offset:0
v_mfma_f32_16x16x32_bf16 v[28:31], v[128:131], v[132:135], v[28:31]
ds_read_b128 v[176:179], v18 offset:2048
v_mfma_f32_16x16x32_bf16 v[32:35], v[124:127], v[152:155], v[32:35]
ds_read_b128 v[180:183], v20 offset:0
v_mfma_f32_16x16x32_bf16 v[36:39], v[128:131], v[152:155], v[36:39]
ds_read_b128 v[200:203], v20 offset:10240
v_mfma_f32_16x16x32_bf16 v[104:107], v[120:123], v[124:127], v[104:107]
ds_read_b128 v[184:187], v20 offset:1024
v_mfma_f32_16x16x32_bf16 v[40:43], v[124:127], v[136:139], v[40:43]
ds_read_b128 v[204:207], v20 offset:11264
v_mfma_f32_16x16x32_bf16 v[44:47], v[128:131], v[136:139], v[44:47]
ds_read_b128 v[188:191], v20 offset:2048
v_mfma_f32_16x16x32_bf16 v[48:51], v[124:127], v[156:159], v[48:51]
ds_read_b128 v[208:211], v20 offset:12288
v_mfma_f32_16x16x32_bf16 v[52:55], v[128:131], v[156:159], v[52:55]
ds_read_b128 v[192:195], v20 offset:3072
v_mfma_f32_16x16x32_bf16 v[108:111], v[120:123], v[128:131], v[108:111]
ds_read_b128 v[212:215], v20 offset:13312
v_mfma_f32_16x16x32_bf16 v[56:59], v[124:127], v[140:143], v[56:59]
ds_read_b128 v[196:199], v20 offset:4096
v_mfma_f32_16x16x32_bf16 v[60:63], v[128:131], v[140:143], v[60:63]
ds_read_b128 v[216:219], v20 offset:14336
v_mfma_f32_16x16x32_bf16 v[64:67], v[124:127], v[160:163], v[64:67]
v_add_u32 v17, -110592, v17
v_add_u32 v18, -110592, v18
v_add_u32 v19, -110592, v19
v_mfma_f32_16x16x32_bf16 v[68:71], v[128:131], v[160:163], v[68:71]
v_add_u32 v20, -110592, v20
v_mfma_f32_16x16x32_bf16 v[112:115], v[124:127], v[124:127], v[112:115]
v_mfma_f32_16x16x32_bf16 v[72:75], v[124:127], v[144:147], v[72:75]
v_mfma_f32_16x16x32_bf16 v[76:79], v[128:131], v[144:147], v[76:79]
v_mfma_f32_16x16x32_bf16 v[80:83], v[124:127], v[164:167], v[80:83]
v_mfma_f32_16x16x32_bf16 v[84:87], v[128:131], v[164:167], v[84:87]
v_mfma_f32_16x16x32_bf16 v[116:119], v[128:131], v[128:131], v[116:119]
v_mfma_f32_16x16x32_bf16 v[88:91], v[124:127], v[148:151], v[88:91]
v_mfma_f32_16x16x32_bf16 v[92:95], v[128:131], v[148:151], v[92:95]
v_mfma_f32_16x16x32_bf16 v[96:99], v[124:127], v[168:171], v[96:99]
v_mfma_f32_16x16x32_bf16 v[100:103], v[128:131], v[168:171], v[100:103]
s_waitcnt vmcnt(0) lgkmcnt(0)
s_barrier
s_mov_b64 exec, 0x3fffffff
v_cmp_ne_u32 vcc, s65, v252
s_mov_b64 exec, -1
s_nop 2
s_cbranch_vccnz DF_wsp
DF_wok:
v_mfma_f32_16x16x32_bf16 v[24:27], v[172:175], v[180:183], v[24:27]
ds_read_b128 v[124:127], v17 offset:0
v_mfma_f32_16x16x32_bf16 v[28:31], v[176:179], v[180:183], v[28:31]
ds_read_b128 v[128:131], v17 offset:2048
buffer_load_dwordx4 a[0:3], v254, s[16:19], s94 offen offset:0 sc1
v_mfma_f32_16x16x32_bf16 v[32:35], v[172:175], v[200:203], v[32:35]
ds_read_b128 v[132:135], v19 offset:0
v_mfma_f32_16x16x32_bf16 v[36:39], v[176:179], v[200:203], v[36:39]
ds_read_b128 v[152:155], v19 offset:10240
buffer_load_dwordx4 a[4:7], v254, s[16:19], s94 offen offset:1024 sc1
v_mfma_f32_16x16x32_bf16 v[104:107], v[120:123], v[172:175], v[104:107]
ds_read_b128 v[136:139], v19 offset:1024
v_mfma_f32_16x16x32_bf16 v[40:43], v[172:175], v[184:187], v[40:43]
ds_read_b128 v[156:159], v19 offset:11264
v_mfma_f32_16x16x32_bf16 v[44:47], v[176:179], v[184:187], v[44:47]
ds_read_b128 v[140:143], v19 offset:2048
buffer_load_dwordx4 a[8:11], v254, s[16:19], s94 offen offset:2048 sc1
v_mfma_f32_16x16x32_bf16 v[48:51], v[172:175], v[204:207], v[48:51]
ds_read_b128 v[160:163], v19 offset:12288
v_mfma_f32_16x16x32_bf16 v[52:55], v[176:179], v[204:207], v[52:55]
ds_read_b128 v[144:147], v19 offset:3072
buffer_load_dwordx4 a[12:15], v254, s[16:19], s94 offen offset:3072 sc1
v_add_u32 v254, 4096, v254
v_mfma_f32_16x16x32_bf16 v[108:111], v[120:123], v[176:179], v[108:111]
ds_read_b128 v[164:167], v19 offset:13312
v_mfma_f32_16x16x32_bf16 v[56:59], v[172:175], v[188:191], v[56:59]
ds_read_b128 v[148:151], v19 offset:4096
v_mfma_f32_16x16x32_bf16 v[60:63], v[176:179], v[188:191], v[60:63]
ds_read_b128 v[168:171], v19 offset:14336
buffer_load_dwordx4 a[16:19], v254, s[16:19], s94 offen offset:0 sc1
v_mfma_f32_16x16x32_bf16 v[64:67], v[172:175], v[208:211], v[64:67]
v_mfma_f32_16x16x32_bf16 v[68:71], v[176:179], v[208:211], v[68:71]
v_mfma_f32_16x16x32_bf16 v[112:115], v[172:175], v[172:175], v[112:115]
buffer_load_dwordx4 a[20:23], v254, s[16:19], s94 offen offset:1024 sc1
v_mfma_f32_16x16x32_bf16 v[72:75], v[172:175], v[192:195], v[72:75]
v_mfma_f32_16x16x32_bf16 v[76:79], v[176:179], v[192:195], v[76:79]
buffer_load_dwordx4 a[24:27], v254, s[16:19], s94 offen offset:2048 sc1
v_mfma_f32_16x16x32_bf16 v[80:83], v[172:175], v[212:215], v[80:83]
v_mfma_f32_16x16x32_bf16 v[84:87], v[176:179], v[212:215], v[84:87]
v_mfma_f32_16x16x32_bf16 v[116:119], v[176:179], v[176:179], v[116:119]
buffer_load_dwordx4 a[28:31], v254, s[16:19], s94 offen offset:3072 sc1
v_add_u32 v254, 4096, v254
v_mfma_f32_16x16x32_bf16 v[88:91], v[172:175], v[196:199], v[88:91]
v_mfma_f32_16x16x32_bf16 v[92:95], v[176:179], v[196:199], v[92:95]
v_mfma_f32_16x16x32_bf16 v[96:99], v[172:175], v[216:219], v[96:99]
v_mfma_f32_16x16x32_bf16 v[100:103], v[176:179], v[216:219], v[100:103]
s_waitcnt lgkmcnt(0)
v_mfma_f32_16x16x32_bf16 v[24:27], v[124:127], v[132:135], v[24:27]
ds_read_b128 v[172:175], v18 offset:0
v_mfma_f32_16x16x32_bf16 v[28:31], v[128:131], v[132:135], v[28:31]
ds_read_b128 v[176:179], v18 offset:2048
buffer_load_dwordx4 a[32:35], v254, s[16:19], s94 offen offset:0 sc1
v_mfma_f32_16x16x32_bf16 v[32:35], v[124:127], v[152:155], v[32:35]
ds_read_b128 v[180:183], v20 offset:0
v_mfma_f32_16x16x32_bf16 v[36:39], v[128:131], v[152:155], v[36:39]
ds_read_b128 v[200:203], v20 offset:10240
buffer_load_dwordx4 a[36:39], v254, s[16:19], s94 offen offset:1024 sc1
v_mfma_f32_16x16x32_bf16 v[104:107], v[120:123], v[124:127], v[104:107]
ds_read_b128 v[184:187], v20 offset:1024
v_mfma_f32_16x16x32_bf16 v[40:43], v[124:127], v[136:139], v[40:43]
ds_read_b128 v[204:207], v20 offset:11264
v_mfma_f32_16x16x32_bf16 v[44:47], v[128:131], v[136:139], v[44:47]
ds_read_b128 v[188:191], v20 offset:2048
buffer_load_dwordx4 a[40:43], v254, s[16:19], s94 offen offset:2048 sc1
v_mfma_f32_16x16x32_bf16 v[48:51], v[124:127], v[156:159], v[48:51]
ds_read_b128 v[208:211], v20 offset:12288
v_mfma_f32_16x16x32_bf16 v[52:55], v[128:131], v[156:159], v[52:55]
ds_read_b128 v[192:195], v20 offset:3072
buffer_load_dwordx4 a[44:47], v254, s[16:19], s94 offen offset:3072 sc1
v_add_u32 v254, 4096, v254
v_mfma_f32_16x16x32_bf16 v[108:111], v[120:123], v[128:131], v[108:111]
ds_read_b128 v[212:215], v20 offset:13312
v_mfma_f32_16x16x32_bf16 v[56:59], v[124:127], v[140:143], v[56:59]
ds_read_b128 v[196:199], v20 offset:4096
v_mfma_f32_16x16x32_bf16 v[60:63], v[128:131], v[140:143], v[60:63]
ds_read_b128 v[216:219], v20 offset:14336
buffer_load_dwordx4 a[48:51], v254, s[16:19], s94 offen offset:0 sc1
v_mfma_f32_16x16x32_bf16 v[64:67], v[124:127], v[160:163], v[64:67]
v_add_u32 v17, 36864, v17
v_add_u32 v18, 36864, v18
v_add_u32 v19, 36864, v19
v_mfma_f32_16x16x32_bf16 v[68:71], v[128:131], v[160:163], v[68:71]
v_add_u32 v20, 36864, v20
v_mfma_f32_16x16x32_bf16 v[112:115], v[124:127], v[124:127], v[112:115]
buffer_load_dwordx4 a[52:55], v254, s[16:19], s94 offen offset:1024 sc1
v_mfma_f32_16x16x32_bf16 v[72:75], v[124:127], v[144:147], v[72:75]
v_mfma_f32_16x16x32_bf16 v[76:79], v[128:131], v[144:147], v[76:79]
buffer_load_dwordx4 a[56:59], v254, s[16:19], s94 offen offset:2048 sc1
v_mfma_f32_16x16x32_bf16 v[80:83], v[124:127], v[164:167], v[80:83]
v_mfma_f32_16x16x32_bf16 v[84:87], v[128:131], v[164:167], v[84:87]
v_mfma_f32_16x16x32_bf16 v[116:119], v[128:131], v[128:131], v[116:119]
buffer_load_dwordx4 a[60:63], v254, s[16:19], s94 offen offset:3072 sc1
v_add_u32 v254, 4096, v254
v_mfma_f32_16x16x32_bf16 v[88:91], v[124:127], v[148:151], v[88:91]
v_mfma_f32_16x16x32_bf16 v[92:95], v[128:131], v[148:151], v[92:95]
v_mfma_f32_16x16x32_bf16 v[96:99], v[124:127], v[168:171], v[96:99]
v_mfma_f32_16x16x32_bf16 v[100:103], v[128:131], v[168:171], v[100:103]
s_waitcnt lgkmcnt(0)
s_barrier
v_mfma_f32_16x16x32_bf16 v[24:27], v[172:175], v[180:183], v[24:27]
ds_read_b128 v[124:127], v17 offset:0
v_mfma_f32_16x16x32_bf16 v[28:31], v[176:179], v[180:183], v[28:31]
ds_read_b128 v[128:131], v17 offset:2048
buffer_load_dwordx4 a[64:67], v254, s[16:19], s94 offen offset:0 sc1
v_mfma_f32_16x16x32_bf16 v[32:35], v[172:175], v[200:203], v[32:35]
ds_read_b128 v[132:135], v19 offset:0
v_mfma_f32_16x16x32_bf16 v[36:39], v[176:179], v[200:203], v[36:39]
ds_read_b128 v[152:155], v19 offset:10240
buffer_load_dwordx4 a[68:71], v254, s[16:19], s94 offen offset:1024 sc1
v_mfma_f32_16x16x32_bf16 v[104:107], v[120:123], v[172:175], v[104:107]
ds_read_b128 v[136:139], v19 offset:1024
v_mfma_f32_16x16x32_bf16 v[40:43], v[172:175], v[184:187], v[40:43]
ds_read_b128 v[156:159], v19 offset:11264
v_mfma_f32_16x16x32_bf16 v[44:47], v[176:179], v[184:187], v[44:47]
ds_read_b128 v[140:143], v19 offset:2048
buffer_load_dwordx4 a[72:75], v254, s[16:19], s94 offen offset:2048 sc1
v_mfma_f32_16x16x32_bf16 v[48:51], v[172:175], v[204:207], v[48:51]
ds_read_b128 v[160:163], v19 offset:12288
v_mfma_f32_16x16x32_bf16 v[52:55], v[176:179], v[204:207], v[52:55]
ds_read_b128 v[144:147], v19 offset:3072
buffer_load_dwordx4 a[76:79], v254, s[16:19], s94 offen offset:3072 sc1
v_add_u32 v254, 4096, v254
v_mfma_f32_16x16x32_bf16 v[108:111], v[120:123], v[176:179], v[108:111]
ds_read_b128 v[164:167], v19 offset:13312
v_mfma_f32_16x16x32_bf16 v[56:59], v[172:175], v[188:191], v[56:59]
ds_read_b128 v[148:151], v19 offset:4096
v_mfma_f32_16x16x32_bf16 v[60:63], v[176:179], v[188:191], v[60:63]
ds_read_b128 v[168:171], v19 offset:14336
buffer_load_dwordx4 a[80:83], v254, s[16:19], s94 offen offset:0 sc1
v_mfma_f32_16x16x32_bf16 v[64:67], v[172:175], v[208:211], v[64:67]
v_mfma_f32_16x16x32_bf16 v[68:71], v[176:179], v[208:211], v[68:71]
v_mfma_f32_16x16x32_bf16 v[112:115], v[172:175], v[172:175], v[112:115]
buffer_load_dwordx4 a[84:87], v254, s[16:19], s94 offen offset:1024 sc1
v_mfma_f32_16x16x32_bf16 v[72:75], v[172:175], v[192:195], v[72:75]
v_mfma_f32_16x16x32_bf16 v[76:79], v[176:179], v[192:195], v[76:79]
buffer_load_dwordx4 a[88:91], v254, s[16:19], s94 offen offset:2048 sc1
v_mfma_f32_16x16x32_bf16 v[80:83], v[172:175], v[212:215], v[80:83]
v_mfma_f32_16x16x32_bf16 v[84:87], v[176:179], v[212:215], v[84:87]
v_mfma_f32_16x16x32_bf16 v[116:119], v[176:179], v[176:179], v[116:119]
buffer_load_dwordx4 a[92:95], v254, s[16:19], s94 offen offset:3072 sc1
v_add_u32 v254, 4096, v254
v_mfma_f32_16x16x32_bf16 v[88:91], v[172:175], v[196:199], v[88:91]
v_mfma_f32_16x16x32_bf16 v[92:95], v[176:179], v[196:199], v[92:95]
v_mfma_f32_16x16x32_bf16 v[96:99], v[172:175], v[216:219], v[96:99]
v_mfma_f32_16x16x32_bf16 v[100:103], v[176:179], v[216:219], v[100:103]
s_waitcnt lgkmcnt(0)
v_mfma_f32_16x16x32_bf16 v[24:27], v[124:127], v[132:135], v[24:27]
ds_read_b128 v[172:175], v18 offset:0
v_mfma_f32_16x16x32_bf16 v[28:31], v[128:131], v[132:135], v[28:31]
ds_read_b128 v[176:179], v18 offset:2048
buffer_load_dwordx4 a[96:99], v254, s[16:19], s94 offen offset:0 sc1
v_mfma_f32_16x16x32_bf16 v[32:35], v[124:127], v[152:155], v[32:35]
ds_read_b128 v[180:183], v20 offset:0
v_mfma_f32_16x16x32_bf16 v[36:39], v[128:131], v[152:155], v[36:39]
ds_read_b128 v[200:203], v20 offset:10240
buffer_load_dwordx4 a[100:103], v254, s[16:19], s94 offen offset:1024 sc1
v_mfma_f32_16x16x32_bf16 v[104:107], v[120:123], v[124:127], v[104:107]
ds_read_b128 v[184:187], v20 offset:1024
v_mfma_f32_16x16x32_bf16 v[40:43], v[124:127], v[136:139], v[40:43]
ds_read_b128 v[204:207], v20 offset:11264
v_mfma_f32_16x16x32_bf16 v[44:47], v[128:131], v[136:139], v[44:47]
ds_read_b128 v[188:191], v20 offset:2048
buffer_load_dwordx4 a[104:107], v254, s[16:19], s94 offen offset:2048 sc1
v_mfma_f32_16x16x32_bf16 v[48:51], v[124:127], v[156:159], v[48:51]
ds_read_b128 v[208:211], v20 offset:12288
v_mfma_f32_16x16x32_bf16 v[52:55], v[128:131], v[156:159], v[52:55]
ds_read_b128 v[192:195], v20 offset:3072
buffer_load_dwordx4 a[108:111], v254, s[16:19], s94 offen offset:3072 sc1
v_add_u32 v254, 4096, v254
v_mfma_f32_16x16x32_bf16 v[108:111], v[120:123], v[128:131], v[108:111]
ds_read_b128 v[212:215], v20 offset:13312
v_mfma_f32_16x16x32_bf16 v[56:59], v[124:127], v[140:143], v[56:59]
ds_read_b128 v[196:199], v20 offset:4096
v_mfma_f32_16x16x32_bf16 v[60:63], v[128:131], v[140:143], v[60:63]
ds_read_b128 v[216:219], v20 offset:14336
buffer_load_dwordx4 a[112:115], v254, s[16:19], s94 offen offset:0 sc1
v_mfma_f32_16x16x32_bf16 v[64:67], v[124:127], v[160:163], v[64:67]
v_mfma_f32_16x16x32_bf16 v[68:71], v[128:131], v[160:163], v[68:71]
v_mfma_f32_16x16x32_bf16 v[112:115], v[124:127], v[124:127], v[112:115]
buffer_load_dwordx4 a[116:119], v254, s[16:19], s94 offen offset:1024 sc1
v_mfma_f32_16x16x32_bf16 v[72:75], v[124:127], v[144:147], v[72:75]
v_mfma_f32_16x16x32_bf16 v[76:79], v[128:131], v[144:147], v[76:79]
buffer_load_dwordx4 a[120:123], v254, s[16:19], s94 offen offset:2048 sc1
v_mfma_f32_16x16x32_bf16 v[80:83], v[124:127], v[164:167], v[80:83]
v_mfma_f32_16x16x32_bf16 v[84:87], v[128:131], v[164:167], v[84:87]
v_mfma_f32_16x16x32_bf16 v[116:119], v[128:131], v[128:131], v[116:119]
buffer_load_dwordx4 a[124:127], v254, s[16:19], s94 offen offset:3072 sc1
v_add_u32 v254, 4096, v254
v_mfma_f32_16x16x32_bf16 v[88:91], v[124:127], v[148:151], v[88:91]
v_mfma_f32_16x16x32_bf16 v[92:95], v[128:131], v[148:151], v[92:95]
v_mfma_f32_16x16x32_bf16 v[96:99], v[124:127], v[168:171], v[96:99]
v_mfma_f32_16x16x32_bf16 v[100:103], v[128:131], v[168:171], v[100:103]
s_waitcnt lgkmcnt(0)
s_barrier
v_mfma_f32_16x16x32_bf16 v[24:27], v[172:175], v[180:183], v[24:27]
v_mfma_f32_16x16x32_bf16 v[28:31], v[176:179], v[180:183], v[28:31]
buffer_load_dwordx4 a[128:131], v254, s[16:19], s94 offen offset:0 sc1
v_mfma_f32_16x16x32_bf16 v[32:35], v[172:175], v[200:203], v[32:35]
v_mfma_f32_16x16x32_bf16 v[36:39], v[176:179], v[200:203], v[36:39]
buffer_load_dwordx4 a[132:135], v254, s[16:19], s94 offen offset:1024 sc1
v_mfma_f32_16x16x32_bf16 v[104:107], v[120:123], v[172:175], v[104:107]
v_mfma_f32_16x16x32_bf16 v[40:43], v[172:175], v[184:187], v[40:43]
v_mfma_f32_16x16x32_bf16 v[44:47], v[176:179], v[184:187], v[44:47]
buffer_load_dwordx4 a[136:139], v254, s[16:19], s94 offen offset:2048 sc1
v_mfma_f32_16x16x32_bf16 v[48:51], v[172:175], v[204:207], v[48:51]
v_mfma_f32_16x16x32_bf16 v[52:55], v[176:179], v[204:207], v[52:55]
buffer_load_dwordx4 a[140:143], v254, s[16:19], s94 offen offset:3072 sc1
v_add_u32 v254, 4096, v254
v_mfma_f32_16x16x32_bf16 v[108:111], v[120:123], v[176:179], v[108:111]
v_mfma_f32_16x16x32_bf16 v[56:59], v[172:175], v[188:191], v[56:59]
v_mfma_f32_16x16x32_bf16 v[60:63], v[176:179], v[188:191], v[60:63]
buffer_load_dwordx4 a[144:147], v254, s[16:19], s94 offen offset:0 sc1
v_mfma_f32_16x16x32_bf16 v[64:67], v[172:175], v[208:211], v[64:67]
v_mfma_f32_16x16x32_bf16 v[68:71], v[176:179], v[208:211], v[68:71]
v_mfma_f32_16x16x32_bf16 v[112:115], v[172:175], v[172:175], v[112:115]
buffer_load_dwordx4 a[148:151], v254, s[16:19], s94 offen offset:1024 sc1
v_mfma_f32_16x16x32_bf16 v[72:75], v[172:175], v[192:195], v[72:75]
v_mfma_f32_16x16x32_bf16 v[76:79], v[176:179], v[192:195], v[76:79]
buffer_load_dwordx4 a[152:155], v254, s[16:19], s94 offen offset:2048 sc1
v_mfma_f32_16x16x32_bf16 v[80:83], v[172:175], v[212:215], v[80:83]
v_mfma_f32_16x16x32_bf16 v[84:87], v[176:179], v[212:215], v[84:87]
v_mfma_f32_16x16x32_bf16 v[116:119], v[176:179], v[176:179], v[116:119]
buffer_load_dwordx4 a[156:159], v254, s[16:19], s94 offen offset:3072 sc1
v_add_u32 v254, 4096, v254
v_mfma_f32_16x16x32_bf16 v[88:91], v[172:175], v[196:199], v[88:91]
v_mfma_f32_16x16x32_bf16 v[92:95], v[176:179], v[196:199], v[92:95]
v_mfma_f32_16x16x32_bf16 v[96:99], v[172:175], v[216:219], v[96:99]
v_mfma_f32_16x16x32_bf16 v[100:103], v[176:179], v[216:219], v[100:103]
s_nop 7
s_nop 7
v_cndmask_b32 v236, v112, v113, s[50:51]
v_cndmask_b32 v236, v236, v114, s[52:53]
v_cndmask_b32 v236, v236, v115, s[54:55]
v_cndmask_b32 v237, v116, v117, s[50:51]
v_cndmask_b32 v237, v237, v118, s[52:53]
v_cndmask_b32 v237, v237, v119, s[54:55]
ds_bpermute_b32 v238, v247, v236
ds_bpermute_b32 v239, v247, v237
s_waitcnt lgkmcnt(0)
buffer_load_dwordx4 a[160:163], v254, s[16:19], s94 offen offset:0 sc1
v_mul_f32 v240, 0x3acccccd, v104
v_mul_f32 v238, 0x3acccccd, v238
v_fma_f32 v238, -v240, v240, v238
v_max_f32 v238, 0, v238
v_cvt_pk_bf16_f32 v242, v240, v238
v_lshlrev_b32 v248, 16, v242
v_and_b32 v242, 0xffff0000, v242
buffer_load_dwordx4 a[164:167], v254, s[16:19], s94 offen offset:1024 sc1
v_add_f32 v242, 0x3727c5ac, v242
v_cvt_pk_bf16_f32 v242, v242, v242
v_and_b32 v242, 0xffff0000, v242
v_sqrt_f32 v242, v242
s_nop 0
v_cvt_pk_bf16_f32 v242, v242, v242
v_and_b32 v242, 0xffff0000, v242
buffer_load_dwordx4 a[168:171], v254, s[16:19], s94 offen offset:2048 sc1
v_rcp_f32 v250, v242
v_mul_f32 v241, 0x3acccccd, v108
v_mul_f32 v239, 0x3acccccd, v239
v_fma_f32 v239, -v241, v241, v239
v_max_f32 v239, 0, v239
v_cvt_pk_bf16_f32 v243, v241, v239
v_lshlrev_b32 v249, 16, v243
buffer_load_dwordx4 a[172:175], v254, s[16:19], s94 offen offset:3072 sc1
v_add_u32 v254, 4096, v254
v_and_b32 v243, 0xffff0000, v243
v_add_f32 v243, 0x3727c5ac, v243
v_cvt_pk_bf16_f32 v243, v243, v243
v_and_b32 v243, 0xffff0000, v243
v_sqrt_f32 v243, v243
s_nop 0
v_cvt_pk_bf16_f32 v243, v243, v243
buffer_load_dwordx4 a[176:179], v254, s[16:19], s94 offen offset:0 sc1
v_and_b32 v243, 0xffff0000, v243
v_rcp_f32 v251, v243
s_nop 0
v_lshlrev_b32 v5, 4, v2
v_add_u32 v6, 0, v5
ds_bpermute_b32 v124, v6, v250
v_add_u32 v6, 4, v5
ds_bpermute_b32 v125, v6, v250
v_add_u32 v6, 8, v5
ds_bpermute_b32 v126, v6, v250
v_add_u32 v6, 12, v5
ds_bpermute_b32 v127, v6, v250
v_add_u32 v6, 0, v5
ds_bpermute_b32 v128, v6, v251
v_add_u32 v6, 4, v5
ds_bpermute_b32 v129, v6, v251
v_add_u32 v6, 8, v5
ds_bpermute_b32 v130, v6, v251
v_add_u32 v6, 12, v5
ds_bpermute_b32 v131, v6, v251
v_xor_b32 v236, 0x80008000, v228
v_xor_b32 v237, 0x80008000, v229
v_xor_b32 v238, 0x80008000, v230
v_xor_b32 v239, 0x80008000, v231
v_xor_b32 v240, 0x80008000, v232
v_xor_b32 v241, 0x80008000, v233
v_xor_b32 v242, 0x80008000, v234
v_xor_b32 v243, 0x80008000, v235
s_waitcnt lgkmcnt(0)
v_pk_mul_f32 v[24:25], v[24:25], v[124:125]
v_pk_mul_f32 v[26:27], v[26:27], v[126:127]
v_pk_mul_f32 v[28:29], v[28:29], v[128:129]
v_pk_mul_f32 v[30:31], v[30:31], v[130:131]
v_cvt_pk_bf16_f32 v132, v24, v25
v_cvt_pk_bf16_f32 v133, v26, v27
v_cvt_pk_bf16_f32 v134, v28, v29
v_cvt_pk_bf16_f32 v135, v30, v31
v_pk_mul_f32 v[32:33], v[32:33], v[124:125]
v_pk_mul_f32 v[34:35], v[34:35], v[126:127]
v_pk_mul_f32 v[36:37], v[36:37], v[128:129]
v_pk_mul_f32 v[38:39], v[38:39], v[130:131]
v_cvt_pk_bf16_f32 v136, v32, v33
v_cvt_pk_bf16_f32 v137, v34, v35
v_cvt_pk_bf16_f32 v138, v36, v37
v_cvt_pk_bf16_f32 v139, v38, v39
v_pk_mul_f32 v[40:41], v[40:41], v[124:125]
v_pk_mul_f32 v[42:43], v[42:43], v[126:127]
v_pk_mul_f32 v[44:45], v[44:45], v[128:129]
v_pk_mul_f32 v[46:47], v[46:47], v[130:131]
v_cvt_pk_bf16_f32 v140, v40, v41
v_cvt_pk_bf16_f32 v141, v42, v43
v_cvt_pk_bf16_f32 v142, v44, v45
v_cvt_pk_bf16_f32 v143, v46, v47
v_pk_mul_f32 v[48:49], v[48:49], v[124:125]
v_pk_mul_f32 v[50:51], v[50:51], v[126:127]
v_pk_mul_f32 v[52:53], v[52:53], v[128:129]
v_pk_mul_f32 v[54:55], v[54:55], v[130:131]
v_cvt_pk_bf16_f32 v144, v48, v49
v_cvt_pk_bf16_f32 v145, v50, v51
v_cvt_pk_bf16_f32 v146, v52, v53
v_cvt_pk_bf16_f32 v147, v54, v55
v_pk_mul_f32 v[56:57], v[56:57], v[124:125]
v_pk_mul_f32 v[58:59], v[58:59], v[126:127]
v_pk_mul_f32 v[60:61], v[60:61], v[128:129]
v_pk_mul_f32 v[62:63], v[62:63], v[130:131]
v_cvt_pk_bf16_f32 v148, v56, v57
v_cvt_pk_bf16_f32 v149, v58, v59
v_cvt_pk_bf16_f32 v150, v60, v61
v_cvt_pk_bf16_f32 v151, v62, v63
v_pk_mul_f32 v[64:65], v[64:65], v[124:125]
v_pk_mul_f32 v[66:67], v[66:67], v[126:127]
v_pk_mul_f32 v[68:69], v[68:69], v[128:129]
v_pk_mul_f32 v[70:71], v[70:71], v[130:131]
v_cvt_pk_bf16_f32 v152, v64, v65
v_cvt_pk_bf16_f32 v153, v66, v67
v_cvt_pk_bf16_f32 v154, v68, v69
v_cvt_pk_bf16_f32 v155, v70, v71
v_pk_mul_f32 v[72:73], v[72:73], v[124:125]
v_pk_mul_f32 v[74:75], v[74:75], v[126:127]
v_pk_mul_f32 v[76:77], v[76:77], v[128:129]
v_pk_mul_f32 v[78:79], v[78:79], v[130:131]
v_cvt_pk_bf16_f32 v156, v72, v73
v_cvt_pk_bf16_f32 v157, v74, v75
v_cvt_pk_bf16_f32 v158, v76, v77
v_cvt_pk_bf16_f32 v159, v78, v79
v_pk_mul_f32 v[80:81], v[80:81], v[124:125]
v_pk_mul_f32 v[82:83], v[82:83], v[126:127]
v_pk_mul_f32 v[84:85], v[84:85], v[128:129]
v_pk_mul_f32 v[86:87], v[86:87], v[130:131]
v_cvt_pk_bf16_f32 v160, v80, v81
v_cvt_pk_bf16_f32 v161, v82, v83
v_cvt_pk_bf16_f32 v162, v84, v85
v_cvt_pk_bf16_f32 v163, v86, v87
v_pk_mul_f32 v[88:89], v[88:89], v[124:125]
v_pk_mul_f32 v[90:91], v[90:91], v[126:127]
v_pk_mul_f32 v[92:93], v[92:93], v[128:129]
v_pk_mul_f32 v[94:95], v[94:95], v[130:131]
v_cvt_pk_bf16_f32 v164, v88, v89
v_cvt_pk_bf16_f32 v165, v90, v91
v_cvt_pk_bf16_f32 v166, v92, v93
v_cvt_pk_bf16_f32 v167, v94, v95
v_pk_mul_f32 v[96:97], v[96:97], v[124:125]
v_pk_mul_f32 v[98:99], v[98:99], v[126:127]
v_pk_mul_f32 v[100:101], v[100:101], v[128:129]
v_pk_mul_f32 v[102:103], v[102:103], v[130:131]
v_cvt_pk_bf16_f32 v168, v96, v97
v_cvt_pk_bf16_f32 v169, v98, v99
v_cvt_pk_bf16_f32 v170, v100, v101
v_cvt_pk_bf16_f32 v171, v102, v103
s_nop 1
s_movk_i32 s56, 1296
s_mov_b32 s57, 81920
s_lshl_b32 s63, s24, 3
v_mfma_f32_16x16x32_bf16 v[24:27], v[132:135], v[220:223], 0
v_add_u32 v5, 0, v0
v_mul_u32_u24 v6, 205, v5
v_mfma_f32_16x16x32_bf16 v[28:31], v[132:135], v[228:231], 0
v_lshrrev_b32 v6, 14, v6
v_mul_u32_u24 v7, 80, v6
v_mfma_f32_16x16x32_bf16 v[32:35], v[132:135], v[224:227], 0
v_sub_u32 v5, v5, v7
v_lshlrev_b32 v5, 4, v5
v_add_u32 v6, s63, v6
v_mfma_f32_16x16x32_bf16 v[36:39], v[132:135], v[232:235], 0
v_mad_u32_u24 v180, v6, s56, v5
v_mad_u32_u24 v190, v6, s57, v5
v_mfma_f32_16x16x32_bf16 v[24:27], v[136:139], v[236:239], v[24:27]
v_add_u32 v5, 64, v0
v_mul_u32_u24 v6, 205, v5
v_mfma_f32_16x16x32_bf16 v[28:31], v[136:139], v[220:223], v[28:31]
v_lshrrev_b32 v6, 14, v6
v_mul_u32_u24 v7, 80, v6
v_mfma_f32_16x16x32_bf16 v[32:35], v[136:139], v[240:243], v[32:35]
v_sub_u32 v5, v5, v7
v_lshlrev_b32 v5, 4, v5
v_add_u32 v6, s63, v6
v_mfma_f32_16x16x32_bf16 v[36:39], v[136:139], v[224:227], v[36:39]
v_mad_u32_u24 v181, v6, s56, v5
v_mad_u32_u24 v191, v6, s57, v5
v_mfma_f32_16x16x32_bf16 v[40:43], v[140:143], v[220:223], 0
v_add_u32 v5, 128, v0
v_mul_u32_u24 v6, 205, v5
v_mfma_f32_16x16x32_bf16 v[44:47], v[140:143], v[228:231], 0
v_lshrrev_b32 v6, 14, v6
v_mul_u32_u24 v7, 80, v6
v_mfma_f32_16x16x32_bf16 v[48:51], v[140:143], v[224:227], 0
v_sub_u32 v5, v5, v7
v_lshlrev_b32 v5, 4, v5
v_add_u32 v6, s63, v6
v_mfma_f32_16x16x32_bf16 v[52:55], v[140:143], v[232:235], 0
v_mad_u32_u24 v182, v6, s56, v5
v_mad_u32_u24 v192, v6, s57, v5
v_mfma_f32_16x16x32_bf16 v[40:43], v[144:147], v[236:239], v[40:43]
v_add_u32 v5, 192, v0
v_mul_u32_u24 v6, 205, v5
v_mfma_f32_16x16x32_bf16 v[44:47], v[144:147], v[220:223], v[44:47]
v_lshrrev_b32 v6, 14, v6
v_mul_u32_u24 v7, 80, v6
v_mfma_f32_16x16x32_bf16 v[48:51], v[144:147], v[240:243], v[48:51]
v_sub_u32 v5, v5, v7
v_lshlrev_b32 v5, 4, v5
v_add_u32 v6, s63, v6
v_mfma_f32_16x16x32_bf16 v[52:55], v[144:147], v[224:227], v[52:55]
v_mad_u32_u24 v183, v6, s56, v5
v_mad_u32_u24 v193, v6, s57, v5
v_mfma_f32_16x16x32_bf16 v[56:59], v[148:151], v[220:223], 0
v_add_u32 v5, 256, v0
v_mul_u32_u24 v6, 205, v5
v_mfma_f32_16x16x32_bf16 v[60:63], v[148:151], v[228:231], 0
v_lshrrev_b32 v6, 14, v6
v_mul_u32_u24 v7, 80, v6
v_mfma_f32_16x16x32_bf16 v[64:67], v[148:151], v[224:227], 0
v_sub_u32 v5, v5, v7
v_lshlrev_b32 v5, 4, v5
v_add_u32 v6, s63, v6
v_mfma_f32_16x16x32_bf16 v[68:71], v[148:151], v[232:235], 0
v_mad_u32_u24 v184, v6, s56, v5
v_mad_u32_u24 v194, v6, s57, v5
v_mfma_f32_16x16x32_bf16 v[56:59], v[152:155], v[236:239], v[56:59]
v_add_u32 v5, 320, v0
v_mul_u32_u24 v6, 205, v5
v_mfma_f32_16x16x32_bf16 v[60:63], v[152:155], v[220:223], v[60:63]
v_lshrrev_b32 v6, 14, v6
v_mul_u32_u24 v7, 80, v6
v_mfma_f32_16x16x32_bf16 v[64:67], v[152:155], v[240:243], v[64:67]
v_sub_u32 v5, v5, v7
v_lshlrev_b32 v5, 4, v5
v_add_u32 v6, s63, v6
v_mfma_f32_16x16x32_bf16 v[68:71], v[152:155], v[224:227], v[68:71]
v_mad_u32_u24 v185, v6, s56, v5
v_mad_u32_u24 v195, v6, s57, v5
v_mfma_f32_16x16x32_bf16 v[72:75], v[156:159], v[220:223], 0
v_add_u32 v5, 384, v0
v_mul_u32_u24 v6, 205, v5
v_mfma_f32_16x16x32_bf16 v[76:79], v[156:159], v[228:231], 0
v_lshrrev_b32 v6, 14, v6
v_mul_u32_u24 v7, 80, v6
v_mfma_f32_16x16x32_bf16 v[80:83], v[156:159], v[224:227], 0
v_sub_u32 v5, v5, v7
v_lshlrev_b32 v5, 4, v5
v_add_u32 v6, s63, v6
v_mfma_f32_16x16x32_bf16 v[84:87], v[156:159], v[232:235], 0
v_mad_u32_u24 v186, v6, s56, v5
v_mad_u32_u24 v196, v6, s57, v5
v_mfma_f32_16x16x32_bf16 v[72:75], v[160:163], v[236:239], v[72:75]
v_add_u32 v5, 448, v0
v_mul_u32_u24 v6, 205, v5
v_mfma_f32_16x16x32_bf16 v[76:79], v[160:163], v[220:223], v[76:79]
v_lshrrev_b32 v6, 14, v6
v_mul_u32_u24 v7, 80, v6
v_mfma_f32_16x16x32_bf16 v[80:83], v[160:163], v[240:243], v[80:83]
v_sub_u32 v5, v5, v7
v_lshlrev_b32 v5, 4, v5
v_add_u32 v6, s63, v6
v_mfma_f32_16x16x32_bf16 v[84:87], v[160:163], v[224:227], v[84:87]
v_mad_u32_u24 v187, v6, s56, v5
v_mad_u32_u24 v197, v6, s57, v5
v_mfma_f32_16x16x32_bf16 v[88:91], v[164:167], v[220:223], 0
v_add_u32 v5, 512, v0
v_mul_u32_u24 v6, 205, v5
v_mfma_f32_16x16x32_bf16 v[92:95], v[164:167], v[228:231], 0
v_lshrrev_b32 v6, 14, v6
v_mul_u32_u24 v7, 80, v6
v_mfma_f32_16x16x32_bf16 v[96:99], v[164:167], v[224:227], 0
v_sub_u32 v5, v5, v7
v_lshlrev_b32 v5, 4, v5
v_add_u32 v6, s63, v6
v_mfma_f32_16x16x32_bf16 v[100:103], v[164:167], v[232:235], 0
v_mad_u32_u24 v188, v6, s56, v5
v_mad_u32_u24 v198, v6, s57, v5
v_mfma_f32_16x16x32_bf16 v[88:91], v[168:171], v[236:239], v[88:91]
v_add_u32 v5, 576, v0
v_mul_u32_u24 v6, 205, v5
v_mfma_f32_16x16x32_bf16 v[92:95], v[168:171], v[220:223], v[92:95]
v_lshrrev_b32 v6, 14, v6
v_mul_u32_u24 v7, 80, v6
v_mfma_f32_16x16x32_bf16 v[96:99], v[168:171], v[240:243], v[96:99]
v_sub_u32 v5, v5, v7
v_lshlrev_b32 v5, 4, v5
v_add_u32 v6, s63, v6
v_mfma_f32_16x16x32_bf16 v[100:103], v[168:171], v[224:227], v[100:103]
v_mad_u32_u24 v189, v6, s56, v5
v_mad_u32_u24 v199, v6, s57, v5
s_mov_b32 s14, 2621440
s_mov_b32 s12, s86
s_mov_b32 s13, s87
s_add_u32 s12, s12, 6291456
s_addc_u32 s13, s13, 0
s_mul_i32 s62, s26, 20480
s_mul_i32 s63, s25, 1280
s_add_u32 s62, s62, s63
s_mul_i32 s63, s24, 320
v_mul_u32_u24 v5, 1296, v1
v_lshl_add_u32 v5, v2, 4, v5
v_add_u32 v5, s63, v5
s_nop 7
v_cvt_pk_bf16_f32 v200, v24, v25
v_cvt_pk_bf16_f32 v201, v26, v27
v_cvt_pk_bf16_f32 v202, v28, v29
v_cvt_pk_bf16_f32 v203, v30, v31
ds_write_b128 v5, v[200:203] offset:0
v_cvt_pk_bf16_f32 v204, v32, v33
v_cvt_pk_bf16_f32 v205, v34, v35
v_cvt_pk_bf16_f32 v206, v36, v37
v_cvt_pk_bf16_f32 v207, v38, v39
ds_write_b128 v5, v[204:207] offset:20736
v_cvt_pk_bf16_f32 v208, v40, v41
v_cvt_pk_bf16_f32 v209, v42, v43
v_cvt_pk_bf16_f32 v210, v44, v45
v_cvt_pk_bf16_f32 v211, v46, v47
ds_write_b128 v5, v[208:211] offset:64
v_cvt_pk_bf16_f32 v212, v48, v49
v_cvt_pk_bf16_f32 v213, v50, v51
v_cvt_pk_bf16_f32 v214, v52, v53
v_cvt_pk_bf16_f32 v215, v54, v55
ds_write_b128 v5, v[212:215] offset:20800
v_cvt_pk_bf16_f32 v200, v56, v57
v_cvt_pk_bf16_f32 v201, v58, v59
v_cvt_pk_bf16_f32 v202, v60, v61
v_cvt_pk_bf16_f32 v203, v62, v63
ds_write_b128 v5, v[200:203] offset:128
v_cvt_pk_bf16_f32 v204, v64, v65
v_cvt_pk_bf16_f32 v205, v66, v67
v_cvt_pk_bf16_f32 v206, v68, v69
v_cvt_pk_bf16_f32 v207, v70, v71
ds_write_b128 v5, v[204:207] offset:20864
v_cvt_pk_bf16_f32 v208, v72, v73
v_cvt_pk_bf16_f32 v209, v74, v75
v_cvt_pk_bf16_f32 v210, v76, v77
v_cvt_pk_bf16_f32 v211, v78, v79
ds_write_b128 v5, v[208:211] offset:192
v_cvt_pk_bf16_f32 v212, v80, v81
v_cvt_pk_bf16_f32 v213, v82, v83
v_cvt_pk_bf16_f32 v214, v84, v85
v_cvt_pk_bf16_f32 v215, v86, v87
ds_write_b128 v5, v[212:215] offset:20928
v_cvt_pk_bf16_f32 v200, v88, v89
v_cvt_pk_bf16_f32 v201, v90, v91
v_cvt_pk_bf16_f32 v202, v92, v93
v_cvt_pk_bf16_f32 v203, v94, v95
ds_write_b128 v5, v[200:203] offset:256
v_cvt_pk_bf16_f32 v204, v96, v97
v_cvt_pk_bf16_f32 v205, v98, v99
v_cvt_pk_bf16_f32 v206, v100, v101
v_cvt_pk_bf16_f32 v207, v102, v103
ds_write_b128 v5, v[204:207] offset:20992
s_waitcnt lgkmcnt(0)
s_barrier
ds_read_b128 v[132:135], v180
ds_read_b128 v[136:139], v181
ds_read_b128 v[140:143], v182
ds_read_b128 v[144:147], v183
ds_read_b128 v[148:151], v184
ds_read_b128 v[152:155], v185
ds_read_b128 v[156:159], v186
ds_read_b128 v[160:163], v187
ds_read_b128 v[164:167], v188
ds_read_b128 v[168:171], v189
s_waitcnt lgkmcnt(9)
buffer_store_dwordx4 v[132:135], v190, s[12:15], s62 offen sc1
s_waitcnt lgkmcnt(8)
buffer_store_dwordx4 v[136:139], v191, s[12:15], s62 offen sc1
s_waitcnt lgkmcnt(7)
buffer_store_dwordx4 v[140:143], v192, s[12:15], s62 offen sc1
s_waitcnt lgkmcnt(6)
buffer_store_dwordx4 v[144:147], v193, s[12:15], s62 offen sc1
s_waitcnt lgkmcnt(5)
buffer_store_dwordx4 v[148:151], v194, s[12:15], s62 offen sc1
s_waitcnt lgkmcnt(4)
buffer_store_dwordx4 v[152:155], v195, s[12:15], s62 offen sc1
s_waitcnt lgkmcnt(3)
buffer_store_dwordx4 v[156:159], v196, s[12:15], s62 offen sc1
s_waitcnt lgkmcnt(2)
buffer_store_dwordx4 v[160:163], v197, s[12:15], s62 offen sc1
s_waitcnt lgkmcnt(1)
buffer_store_dwordx4 v[164:167], v198, s[12:15], s62 offen sc1
s_waitcnt lgkmcnt(0)
buffer_store_dwordx4 v[168:171], v199, s[12:15], s62 offen sc1
s_lshl_b32 s57, s26, 4
s_add_u32 s57, s57, s25
s_lshl_b32 s57, s57, 4
s_add_u32 s93, s57, 11538432
s_sub_u32 s56, 32, s90
s_and_b32 s56, s56, 31
s_mul_i32 s57, s91, 20
s_sub_u32 s58, 140, s57
s_cmp_ge_u32 s91, 4
s_cselect_b32 s27, 1, 0
s_cselect_b32 s28, s56, s90
s_cselect_b32 s29, s58, s57
s_and_b32 s56, s24, 1
s_lshl_b32 s56, s56, 10
s_lshr_b32 s57, s24, 1
s_lshl_b32 s57, s57, 5
s_add_u32 s30, s56, s57
s_add_u32 s30, s30, s90
v_lshlrev_b32 v5, 6, v1
v_add_u32 v5, s30, v5
v_lshlrev_b32 v5, 12, v5
v_lshrrev_b32 v6, 1, v2
v_lshl_add_u32 v5, v6, 4, v5
v_and_b32 v6, 1, v2
v_cmp_eq_u32 vcc, 0, v6
s_nop 1
s_mov_b64 exec, vcc
global_load_dwordx4 a[240:243], v5, s[38:39] offset:0
global_load_dwordx4 a[244:247], v5, s[38:39] offset:32
global_load_dwordx4 a[248:251], v5, s[38:39] offset:64
global_load_dwordx4 a[252:255], v5, s[38:39] offset:96
s_not_b64 exec, exec
global_load_dwordx4 a[240:243], v5, s[40:41] offset:0
global_load_dwordx4 a[244:247], v5, s[40:41] offset:32
global_load_dwordx4 a[248:251], v5, s[40:41] offset:64
global_load_dwordx4 a[252:255], v5, s[40:41] offset:96
s_mov_b64 exec, -1
s_mov_b32 s4, s86
s_mov_b32 s5, s87
s_mov_b32 s6, 6291456
s_mov_b32 s8, s86
s_mov_b32 s9, s87
s_add_u32 s8, s8, 6291456
s_addc_u32 s9, s9, 0
s_mov_b32 s10, 2621440
v_mov_b32 v7, 81920
v_mul_u32_u24 v13, v7, v1
v_lshl_add_u32 v13, v2, 3, v13
s_mul_i32 s31, s30, 1280
s_mul_i32 s56, s91, 160
s_add_u32 s31, s31, s56
s_mul_i32 s32, s28, 81920
s_mul_i32 s56, s24, 448
v_add_u32 v5, s56, v0
s_movk_i32 s35, 20160
v_add_u32 v6, 0, v5
v_mul_u32_u24 v7, 2341, v6
v_lshrrev_b32 v7, 16, v7
v_mul_u32_u24 v3, 28, v7
v_sub_u32 v6, v6, v3
v_add_u32 v6, s29, v6
v_subrev_u32 v3, 80, v6
v_cmp_le_u32 vcc, 80, v6
v_lshlrev_b32 v4, 8, v7
v_cndmask_b32 v6, v6, v3, vcc
v_lshl_add_u32 v4, v7, 6, v4
v_mul_u32_u24 v3, 205, v6
v_lshrrev_b32 v3, 12, v3
v_mad_u32_u24 v4, v3, s35, v4
v_lshl_add_u32 v16, v6, 4, v4
v_add_u32 v6, 64, v5
v_mul_u32_u24 v7, 2341, v6
v_lshrrev_b32 v7, 16, v7
v_mul_u32_u24 v3, 28, v7
v_sub_u32 v6, v6, v3
v_add_u32 v6, s29, v6
v_subrev_u32 v3, 80, v6
v_cmp_le_u32 vcc, 80, v6
v_lshlrev_b32 v4, 8, v7
v_cndmask_b32 v6, v6, v3, vcc
v_lshl_add_u32 v4, v7, 6, v4
v_mul_u32_u24 v3, 205, v6
v_lshrrev_b32 v3, 12, v3
v_mad_u32_u24 v4, v3, s35, v4
v_lshl_add_u32 v20, v6, 4, v4
v_add_u32 v6, 128, v5
v_mul_u32_u24 v7, 2341, v6
v_lshrrev_b32 v7, 16, v7
v_mul_u32_u24 v3, 28, v7
v_sub_u32 v6, v6, v3
v_add_u32 v6, s29, v6
v_subrev_u32 v3, 80, v6
v_cmp_le_u32 vcc, 80, v6
v_lshlrev_b32 v4, 8, v7
v_cndmask_b32 v6, v6, v3, vcc
v_lshl_add_u32 v4, v7, 6, v4
v_mul_u32_u24 v3, 205, v6
v_lshrrev_b32 v3, 12, v3
v_mad_u32_u24 v4, v3, s35, v4
v_lshl_add_u32 v24, v6, 4, v4
v_add_u32 v6, 192, v5
v_mul_u32_u24 v7, 2341, v6
v_lshrrev_b32 v7, 16, v7
v_mul_u32_u24 v3, 28, v7
v_sub_u32 v6, v6, v3
v_add_u32 v6, s29, v6
v_subrev_u32 v3, 80, v6
v_cmp_le_u32 vcc, 80, v6
v_lshlrev_b32 v4, 8, v7
v_cndmask_b32 v6, v6, v3, vcc
v_lshl_add_u32 v4, v7, 6, v4
v_mul_u32_u24 v3, 205, v6
v_lshrrev_b32 v3, 12, v3
v_mad_u32_u24 v4, v3, s35, v4
v_lshl_add_u32 v28, v6, 4, v4
v_add_u32 v6, 256, v5
v_mul_u32_u24 v7, 2341, v6
v_lshrrev_b32 v7, 16, v7
v_mul_u32_u24 v3, 28, v7
v_sub_u32 v6, v6, v3
v_add_u32 v6, s29, v6
v_subrev_u32 v3, 80, v6
v_cmp_le_u32 vcc, 80, v6
v_lshlrev_b32 v4, 8, v7
v_cndmask_b32 v6, v6, v3, vcc
v_lshl_add_u32 v4, v7, 6, v4
v_mul_u32_u24 v3, 205, v6
v_lshrrev_b32 v3, 12, v3
v_mad_u32_u24 v4, v3, s35, v4
v_lshl_add_u32 v32, v6, 4, v4
v_add_u32 v6, 320, v5
v_mul_u32_u24 v7, 2341, v6
v_lshrrev_b32 v7, 16, v7
v_mul_u32_u24 v3, 28, v7
v_sub_u32 v6, v6, v3
v_add_u32 v6, s29, v6
v_subrev_u32 v3, 80, v6
v_cmp_le_u32 vcc, 80, v6
v_lshlrev_b32 v4, 8, v7
v_cndmask_b32 v6, v6, v3, vcc
v_lshl_add_u32 v4, v7, 6, v4
v_mul_u32_u24 v3, 205, v6
v_lshrrev_b32 v3, 12, v3
v_mad_u32_u24 v4, v3, s35, v4
v_lshl_add_u32 v36, v6, 4, v4
v_add_u32 v6, 384, v5
v_mul_u32_u24 v7, 2341, v6
v_lshrrev_b32 v7, 16, v7
v_mul_u32_u24 v3, 28, v7
v_sub_u32 v6, v6, v3
v_add_u32 v6, s29, v6
v_subrev_u32 v3, 80, v6
v_cmp_le_u32 vcc, 80, v6
v_lshlrev_b32 v4, 8, v7
v_cndmask_b32 v6, v6, v3, vcc
v_lshl_add_u32 v4, v7, 6, v4
v_mul_u32_u24 v3, 205, v6
v_lshrrev_b32 v3, 12, v3
v_mad_u32_u24 v4, v3, s35, v4
v_lshl_add_u32 v248, v6, 4, v4
s_add_u32 s56, s24, 0
s_and_b32 s56, s56, 3
s_lshl_b32 s56, s56, 10
v_lshl_add_u32 v8, v0, 4, s56
s_add_u32 s56, s24, 1
s_and_b32 s56, s56, 3
s_lshl_b32 s56, s56, 10
v_lshl_add_u32 v9, v0, 4, s56
s_add_u32 s56, s24, 2
s_and_b32 s56, s56, 3
s_lshl_b32 s56, s56, 10
v_lshl_add_u32 v10, v0, 4, s56
s_add_u32 s56, s24, 3
s_and_b32 s56, s56, 3
s_lshl_b32 s56, s56, 10
v_lshl_add_u32 v11, v0, 4, s56
s_mul_i32 s34, s90, 48
s_mul_i32 s56, s24, 12
s_add_u32 s34, s34, s56
s_lshl_b32 s34, s34, 12
v_lshrrev_b32 v5, 2, v1
v_lshrrev_b32 v6, 1, v2
v_lshl_add_u32 v5, v6, 3, v5
v_mul_u32_u24 v5, 448, v5
v_and_b32 v6, 3, v1
v_lshl_add_u32 v5, v6, 4, v5
v_and_b32 v6, 1, v2
v_lshl_add_u32 v5, v6, 3, v5
v_add_u32 v12, 102400, v5
s_lshr_b32 s56, s90, 2
s_lshl_b32 s56, s56, 9
s_lshl_b32 s57, s24, 7
s_add_u32 s56, s56, s57
s_add_u32 s56, s56, 11534336
v_lshl_add_u32 v14, v0, 4, s56
s_mov_b32 s56, 11538432
v_lshl_add_u32 v15, v0, 4, s56
s_cmp_eq_u32 s27, 0
s_cselect_b32 s33, 0x80008000, 0
s_or_b32 s92, s2, s24
s_waitcnt vmcnt(8)
s_barrier
s_cmp_lg_u32 s24, 0
s_cbranch_scc1 DF_pubd
v_mov_b32 v5, s93
v_mov_b32 v6, s65
s_mov_b64 exec, 1
global_store_dword v5, v6, s[86:87] sc1
s_mov_b64 exec, -1
DF_pubd:
buffer_load_dwordx4 a[180:183], v254, s[16:19], s94 offen offset:1024 sc1
buffer_load_dwordx4 a[184:187], v254, s[16:19], s94 offen offset:2048 sc1
buffer_load_dwordx4 a[188:191], v254, s[16:19], s94 offen offset:3072 sc1
v_add_u32 v254, 4096, v254
buffer_load_dwordx4 a[192:195], v254, s[16:19], s94 offen offset:0 sc1
buffer_load_dwordx4 a[196:199], v254, s[16:19], s94 offen offset:1024 sc1
buffer_load_dwordx4 a[200:203], v254, s[16:19], s94 offen offset:2048 sc1
buffer_load_dwordx4 a[204:207], v254, s[16:19], s94 offen offset:3072 sc1
v_add_u32 v254, 4096, v254
buffer_load_dwordx4 a[208:211], v254, s[16:19], s94 offen offset:0 sc1
buffer_load_dwordx4 a[212:215], v254, s[16:19], s94 offen offset:1024 sc1
buffer_load_dwordx4 a[216:219], v254, s[16:19], s94 offen offset:2048 sc1
buffer_load_dwordx4 a[220:223], v254, s[16:19], s94 offen offset:3072 sc1
v_add_u32 v254, 4096, v254
buffer_load_dwordx4 a[224:227], v254, s[16:19], s94 offen offset:0 sc1
buffer_load_dwordx4 a[228:231], v254, s[16:19], s94 offen offset:1024 sc1
buffer_load_dwordx4 a[232:235], v254, s[16:19], s94 offen offset:2048 sc1
buffer_load_dwordx4 a[236:239], v254, s[16:19], s94 offen offset:3072 sc1
v_add_u32 v254, 4096, v254
K2_start:
s_mov_b32 s62, 0
s_mov_b64 exec, 0x3f
K2_hp:
global_load_dword v252, v14, s[86:87] sc1
s_waitcnt vmcnt(0)
v_cmp_ne_u32 vcc, s65, v252
s_add_u32 s62, s62, 1
s_nop 1
s_cbranch_vccz K2_hpd
s_cmp_lt_u32 s62, 200000
s_cbranch_scc1 K2_hp
K2_hpd:
s_mov_b64 exec, -1
buffer_load_dwordx4 v[120:123], v8, s[4:7], s34 offen sc1
buffer_load_dwordx4 v[124:127], v9, s[4:7], s34 offen sc1
buffer_load_dwordx4 v[128:131], v10, s[4:7], s34 offen sc1
buffer_load_dwordx4 v[132:135], v11, s[4:7], s34 offen sc1
s_add_u32 s34, s34, 4096
buffer_load_dwordx4 v[136:139], v8, s[4:7], s34 offen sc1
buffer_load_dwordx4 v[140:143], v9, s[4:7], s34 offen sc1
buffer_load_dwordx4 v[144:147], v10, s[4:7], s34 offen sc1
buffer_load_dwordx4 v[148:151], v11, s[4:7], s34 offen sc1
s_add_u32 s34, s34, 4096
buffer_load_dwordx4 v[152:155], v8, s[4:7], s34 offen sc1
buffer_load_dwordx4 v[156:159], v9, s[4:7], s34 offen sc1
buffer_load_dwordx4 v[160:163], v10, s[4:7], s34 offen sc1
buffer_load_dwordx4 v[164:167], v11, s[4:7], s34 offen sc1
s_add_u32 s34, s34, 4096
s_waitcnt vmcnt(8)
v_mfma_f32_16x16x32_bf16 v[40:43], a[0:3], v[120:123], 0
v_mfma_f32_16x16x32_bf16 v[60:63], a[0:3], v[124:127], 0
buffer_load_dwordx4 v[168:171], v8, s[4:7], s34 offen sc1
v_mfma_f32_16x16x32_bf16 v[80:83], a[0:3], v[128:131], 0
buffer_load_dwordx4 v[172:175], v9, s[4:7], s34 offen sc1
v_mfma_f32_16x16x32_bf16 v[100:103], a[0:3], v[132:135], 0
buffer_load_dwordx4 v[176:179], v10, s[4:7], s34 offen sc1
v_mfma_f32_16x16x32_bf16 v[44:47], a[4:7], v[120:123], 0
buffer_load_dwordx4 v[180:183], v11, s[4:7], s34 offen sc1
s_add_u32 s34, s34, 4096
v_mfma_f32_16x16x32_bf16 v[64:67], a[4:7], v[124:127], 0
buffer_load_dwordx4 v[184:187], v8, s[4:7], s34 offen sc1
v_mfma_f32_16x16x32_bf16 v[84:87], a[4:7], v[128:131], 0
buffer_load_dwordx4 v[188:191], v9, s[4:7], s34 offen sc1
v_mfma_f32_16x16x32_bf16 v[104:107], a[4:7], v[132:135], 0
buffer_load_dwordx4 v[192:195], v10, s[4:7], s34 offen sc1
v_mfma_f32_16x16x32_bf16 v[48:51], a[8:11], v[120:123], 0
buffer_load_dwordx4 v[196:199], v11, s[4:7], s34 offen sc1
s_add_u32 s34, s34, 4096
v_mfma_f32_16x16x32_bf16 v[68:71], a[8:11], v[124:127], 0
v_mfma_f32_16x16x32_bf16 v[88:91], a[8:11], v[128:131], 0
v_mfma_f32_16x16x32_bf16 v[108:111], a[8:11], v[132:135], 0
v_mfma_f32_16x16x32_bf16 v[52:55], a[12:15], v[120:123], 0
v_mfma_f32_16x16x32_bf16 v[72:75], a[12:15], v[124:127], 0
v_mfma_f32_16x16x32_bf16 v[92:95], a[12:15], v[128:131], 0
v_mfma_f32_16x16x32_bf16 v[112:115], a[12:15], v[132:135], 0
v_mfma_f32_16x16x32_bf16 v[56:59], a[16:19], v[120:123], 0
v_mfma_f32_16x16x32_bf16 v[76:79], a[16:19], v[124:127], 0
v_mfma_f32_16x16x32_bf16 v[96:99], a[16:19], v[128:131], 0
v_mfma_f32_16x16x32_bf16 v[116:119], a[16:19], v[132:135], 0
s_waitcnt vmcnt(12)
v_mfma_f32_16x16x32_bf16 v[40:43], a[20:23], v[136:139], v[40:43]
v_mfma_f32_16x16x32_bf16 v[60:63], a[20:23], v[140:143], v[60:63]
buffer_load_dwordx4 v[200:203], v8, s[4:7], s34 offen sc1
v_mfma_f32_16x16x32_bf16 v[80:83], a[20:23], v[144:147], v[80:83]
buffer_load_dwordx4 v[204:207], v9, s[4:7], s34 offen sc1
v_mfma_f32_16x16x32_bf16 v[100:103], a[20:23], v[148:151], v[100:103]
buffer_load_dwordx4 v[208:211], v10, s[4:7], s34 offen sc1
v_mfma_f32_16x16x32_bf16 v[44:47], a[24:27], v[136:139], v[44:47]
buffer_load_dwordx4 v[212:215], v11, s[4:7], s34 offen sc1
s_add_u32 s34, s34, 4096
v_mfma_f32_16x16x32_bf16 v[64:67], a[24:27], v[140:143], v[64:67]
buffer_load_dwordx4 v[216:219], v8, s[4:7], s34 offen sc1
v_mfma_f32_16x16x32_bf16 v[84:87], a[24:27], v[144:147], v[84:87]
buffer_load_dwordx4 v[220:223], v9, s[4:7], s34 offen sc1
v_mfma_f32_16x16x32_bf16 v[104:107], a[24:27], v[148:151], v[104:107]
buffer_load_dwordx4 v[224:227], v10, s[4:7], s34 offen sc1
v_mfma_f32_16x16x32_bf16 v[48:51], a[28:31], v[136:139], v[48:51]
buffer_load_dwordx4 v[228:231], v11, s[4:7], s34 offen sc1
s_add_u32 s34, s34, 4096
v_mfma_f32_16x16x32_bf16 v[68:71], a[28:31], v[140:143], v[68:71]
v_mfma_f32_16x16x32_bf16 v[88:91], a[28:31], v[144:147], v[88:91]
v_mfma_f32_16x16x32_bf16 v[108:111], a[28:31], v[148:151], v[108:111]
v_mfma_f32_16x16x32_bf16 v[52:55], a[32:35], v[136:139], v[52:55]
v_mfma_f32_16x16x32_bf16 v[72:75], a[32:35], v[140:143], v[72:75]
v_mfma_f32_16x16x32_bf16 v[92:95], a[32:35], v[144:147], v[92:95]
v_mfma_f32_16x16x32_bf16 v[112:115], a[32:35], v[148:151], v[112:115]
v_mfma_f32_16x16x32_bf16 v[56:59], a[36:39], v[136:139], v[56:59]
v_mfma_f32_16x16x32_bf16 v[76:79], a[36:39], v[140:143], v[76:79]
v_mfma_f32_16x16x32_bf16 v[96:99], a[36:39], v[144:147], v[96:99]
v_mfma_f32_16x16x32_bf16 v[116:119], a[36:39], v[148:151], v[116:119]
s_waitcnt vmcnt(16)
v_mfma_f32_16x16x32_bf16 v[40:43], a[40:43], v[152:155], v[40:43]
v_mfma_f32_16x16x32_bf16 v[60:63], a[40:43], v[156:159], v[60:63]
buffer_load_dwordx4 v[232:235], v8, s[4:7], s34 offen sc1
v_mfma_f32_16x16x32_bf16 v[80:83], a[40:43], v[160:163], v[80:83]
buffer_load_dwordx4 v[236:239], v9, s[4:7], s34 offen sc1
v_mfma_f32_16x16x32_bf16 v[100:103], a[40:43], v[164:167], v[100:103]
buffer_load_dwordx4 v[240:243], v10, s[4:7], s34 offen sc1
v_mfma_f32_16x16x32_bf16 v[44:47], a[44:47], v[152:155], v[44:47]
buffer_load_dwordx4 v[244:247], v11, s[4:7], s34 offen sc1
s_add_u32 s34, s34, 4096
v_mfma_f32_16x16x32_bf16 v[64:67], a[44:47], v[156:159], v[64:67]
buffer_load_dwordx4 v[120:123], v8, s[4:7], s34 offen sc1
v_mfma_f32_16x16x32_bf16 v[84:87], a[44:47], v[160:163], v[84:87]
buffer_load_dwordx4 v[124:127], v9, s[4:7], s34 offen sc1
v_mfma_f32_16x16x32_bf16 v[104:107], a[44:47], v[164:167], v[104:107]
buffer_load_dwordx4 v[128:131], v10, s[4:7], s34 offen sc1
v_mfma_f32_16x16x32_bf16 v[48:51], a[48:51], v[152:155], v[48:51]
buffer_load_dwordx4 v[132:135], v11, s[4:7], s34 offen sc1
s_add_u32 s34, s34, 4096
v_mfma_f32_16x16x32_bf16 v[68:71], a[48:51], v[156:159], v[68:71]
v_mfma_f32_16x16x32_bf16 v[88:91], a[48:51], v[160:163], v[88:91]
v_mfma_f32_16x16x32_bf16 v[108:111], a[48:51], v[164:167], v[108:111]
v_mfma_f32_16x16x32_bf16 v[52:55], a[52:55], v[152:155], v[52:55]
v_mfma_f32_16x16x32_bf16 v[72:75], a[52:55], v[156:159], v[72:75]
v_mfma_f32_16x16x32_bf16 v[92:95], a[52:55], v[160:163], v[92:95]
v_mfma_f32_16x16x32_bf16 v[112:115], a[52:55], v[164:167], v[112:115]
v_mfma_f32_16x16x32_bf16 v[56:59], a[56:59], v[152:155], v[56:59]
v_mfma_f32_16x16x32_bf16 v[76:79], a[56:59], v[156:159], v[76:79]
v_mfma_f32_16x16x32_bf16 v[96:99], a[56:59], v[160:163], v[96:99]
v_mfma_f32_16x16x32_bf16 v[116:119], a[56:59], v[164:167], v[116:119]
s_waitcnt vmcnt(20)
v_mfma_f32_16x16x32_bf16 v[40:43], a[60:63], v[168:171], v[40:43]
v_mfma_f32_16x16x32_bf16 v[60:63], a[60:63], v[172:175], v[60:63]
buffer_load_dwordx4 v[136:139], v8, s[4:7], s34 offen sc1
v_mfma_f32_16x16x32_bf16 v[80:83], a[60:63], v[176:179], v[80:83]
buffer_load_dwordx4 v[140:143], v9, s[4:7], s34 offen sc1
v_mfma_f32_16x16x32_bf16 v[100:103], a[60:63], v[180:183], v[100:103]
buffer_load_dwordx4 v[144:147], v10, s[4:7], s34 offen sc1
v_mfma_f32_16x16x32_bf16 v[44:47], a[64:67], v[168:171], v[44:47]
buffer_load_dwordx4 v[148:151], v11, s[4:7], s34 offen sc1
s_add_u32 s34, s34, 4096
v_mfma_f32_16x16x32_bf16 v[64:67], a[64:67], v[172:175], v[64:67]
buffer_load_dwordx4 v[152:155], v8, s[4:7], s34 offen sc1
v_mfma_f32_16x16x32_bf16 v[84:87], a[64:67], v[176:179], v[84:87]
buffer_load_dwordx4 v[156:159], v9, s[4:7], s34 offen sc1
v_mfma_f32_16x16x32_bf16 v[104:107], a[64:67], v[180:183], v[104:107]
buffer_load_dwordx4 v[160:163], v10, s[4:7], s34 offen sc1
v_mfma_f32_16x16x32_bf16 v[48:51], a[68:71], v[168:171], v[48:51]
buffer_load_dwordx4 v[164:167], v11, s[4:7], s34 offen sc1
s_add_u32 s34, s34, 4096
v_mfma_f32_16x16x32_bf16 v[68:71], a[68:71], v[172:175], v[68:71]
v_mfma_f32_16x16x32_bf16 v[88:91], a[68:71], v[176:179], v[88:91]
v_mfma_f32_16x16x32_bf16 v[108:111], a[68:71], v[180:183], v[108:111]
v_mfma_f32_16x16x32_bf16 v[52:55], a[72:75], v[168:171], v[52:55]
v_mfma_f32_16x16x32_bf16 v[72:75], a[72:75], v[172:175], v[72:75]
v_mfma_f32_16x16x32_bf16 v[92:95], a[72:75], v[176:179], v[92:95]
v_mfma_f32_16x16x32_bf16 v[112:115], a[72:75], v[180:183], v[112:115]
v_mfma_f32_16x16x32_bf16 v[56:59], a[76:79], v[168:171], v[56:59]
v_mfma_f32_16x16x32_bf16 v[76:79], a[76:79], v[172:175], v[76:79]
v_mfma_f32_16x16x32_bf16 v[96:99], a[76:79], v[176:179], v[96:99]
v_mfma_f32_16x16x32_bf16 v[116:119], a[76:79], v[180:183], v[116:119]
s_waitcnt vmcnt(24)
v_mfma_f32_16x16x32_bf16 v[40:43], a[80:83], v[184:187], v[40:43]
v_mfma_f32_16x16x32_bf16 v[60:63], a[80:83], v[188:191], v[60:63]
global_load_dword v253, v15, s[86:87] sc1
v_mfma_f32_16x16x32_bf16 v[80:83], a[80:83], v[192:195], v[80:83]
buffer_load_dwordx4 v[168:171], v8, s[4:7], s34 offen sc1
v_mfma_f32_16x16x32_bf16 v[100:103], a[80:83], v[196:199], v[100:103]
buffer_load_dwordx4 v[172:175], v9, s[4:7], s34 offen sc1
v_mfma_f32_16x16x32_bf16 v[44:47], a[84:87], v[184:187], v[44:47]
buffer_load_dwordx4 v[176:179], v10, s[4:7], s34 offen sc1
v_mfma_f32_16x16x32_bf16 v[64:67], a[84:87], v[188:191], v[64:67]
buffer_load_dwordx4 v[180:183], v11, s[4:7], s34 offen sc1
s_add_u32 s34, s34, 4096
v_mfma_f32_16x16x32_bf16 v[84:87], a[84:87], v[192:195], v[84:87]
v_mfma_f32_16x16x32_bf16 v[104:107], a[84:87], v[196:199], v[104:107]
v_mfma_f32_16x16x32_bf16 v[48:51], a[88:91], v[184:187], v[48:51]
v_mfma_f32_16x16x32_bf16 v[68:71], a[88:91], v[188:191], v[68:71]
v_mfma_f32_16x16x32_bf16 v[88:91], a[88:91], v[192:195], v[88:91]
v_mfma_f32_16x16x32_bf16 v[108:111], a[88:91], v[196:199], v[108:111]
v_mfma_f32_16x16x32_bf16 v[52:55], a[92:95], v[184:187], v[52:55]
v_mfma_f32_16x16x32_bf16 v[72:75], a[92:95], v[188:191], v[72:75]
v_mfma_f32_16x16x32_bf16 v[92:95], a[92:95], v[192:195], v[92:95]
v_mfma_f32_16x16x32_bf16 v[112:115], a[92:95], v[196:199], v[112:115]
v_mfma_f32_16x16x32_bf16 v[56:59], a[96:99], v[184:187], v[56:59]
v_mfma_f32_16x16x32_bf16 v[76:79], a[96:99], v[188:191], v[76:79]
v_mfma_f32_16x16x32_bf16 v[96:99], a[96:99], v[192:195], v[96:99]
v_mfma_f32_16x16x32_bf16 v[116:119], a[96:99], v[196:199], v[116:119]
s_waitcnt vmcnt(25)
v_mfma_f32_16x16x32_bf16 v[40:43], a[100:103], v[200:203], v[40:43]
v_mfma_f32_16x16x32_bf16 v[60:63], a[100:103], v[204:207], v[60:63]
v_mfma_f32_16x16x32_bf16 v[80:83], a[100:103], v[208:211], v[80:83]
v_mfma_f32_16x16x32_bf16 v[100:103], a[100:103], v[212:215], v[100:103]
v_mfma_f32_16x16x32_bf16 v[44:47], a[104:107], v[200:203], v[44:47]
v_mfma_f32_16x16x32_bf16 v[64:67], a[104:107], v[204:207], v[64:67]
v_mfma_f32_16x16x32_bf16 v[84:87], a[104:107], v[208:211], v[84:87]
v_mfma_f32_16x16x32_bf16 v[104:107], a[104:107], v[212:215], v[104:107]
v_mfma_f32_16x16x32_bf16 v[48:51], a[108:111], v[200:203], v[48:51]
v_mfma_f32_16x16x32_bf16 v[68:71], a[108:111], v[204:207], v[68:71]
v_mfma_f32_16x16x32_bf16 v[88:91], a[108:111], v[208:211], v[88:91]
v_mfma_f32_16x16x32_bf16 v[108:111], a[108:111], v[212:215], v[108:111]
v_mfma_f32_16x16x32_bf16 v[52:55], a[112:115], v[200:203], v[52:55]
v_mfma_f32_16x16x32_bf16 v[72:75], a[112:115], v[204:207], v[72:75]
v_mfma_f32_16x16x32_bf16 v[92:95], a[112:115], v[208:211], v[92:95]
v_mfma_f32_16x16x32_bf16 v[112:115], a[112:115], v[212:215], v[112:115]
v_mfma_f32_16x16x32_bf16 v[56:59], a[116:119], v[200:203], v[56:59]
v_mfma_f32_16x16x32_bf16 v[76:79], a[116:119], v[204:207], v[76:79]
v_mfma_f32_16x16x32_bf16 v[96:99], a[116:119], v[208:211], v[96:99]
v_mfma_f32_16x16x32_bf16 v[116:119], a[116:119], v[212:215], v[116:119]
s_waitcnt vmcnt(4)
v_cmp_ne_u32 vcc, s65, v253
s_nop 2
s_cbranch_vccnz K2_late
s_waitcnt vmcnt(21)
v_mfma_f32_16x16x32_bf16 v[40:43], a[120:123], v[216:219], v[40:43]
v_mfma_f32_16x16x32_bf16 v[60:63], a[120:123], v[220:223], v[60:63]
buffer_load_dwordx4 v[16:19], v16, s[8:11], s32 offen sc1
v_mfma_f32_16x16x32_bf16 v[80:83], a[120:123], v[224:227], v[80:83]
buffer_load_dwordx4 v[20:23], v20, s[8:11], s32 offen sc1
v_mfma_f32_16x16x32_bf16 v[100:103], a[120:123], v[228:231], v[100:103]
buffer_load_dwordx4 v[24:27], v24, s[8:11], s32 offen sc1
v_mfma_f32_16x16x32_bf16 v[44:47], a[124:127], v[216:219], v[44:47]
buffer_load_dwordx4 v[28:31], v28, s[8:11], s32 offen sc1
v_mfma_f32_16x16x32_bf16 v[64:67], a[124:127], v[220:223], v[64:67]
buffer_load_dwordx4 v[32:35], v32, s[8:11], s32 offen sc1
v_mfma_f32_16x16x32_bf16 v[84:87], a[124:127], v[224:227], v[84:87]
buffer_load_dwordx4 v[36:39], v36, s[8:11], s32 offen sc1
v_mfma_f32_16x16x32_bf16 v[104:107], a[124:127], v[228:231], v[104:107]
buffer_load_dwordx4 v[248:251], v248, s[8:11], s32 offen sc1
v_mfma_f32_16x16x32_bf16 v[48:51], a[128:131], v[216:219], v[48:51]
v_mfma_f32_16x16x32_bf16 v[68:71], a[128:131], v[220:223], v[68:71]
v_mfma_f32_16x16x32_bf16 v[88:91], a[128:131], v[224:227], v[88:91]
v_mfma_f32_16x16x32_bf16 v[108:111], a[128:131], v[228:231], v[108:111]
v_mfma_f32_16x16x32_bf16 v[52:55], a[132:135], v[216:219], v[52:55]
v_mfma_f32_16x16x32_bf16 v[72:75], a[132:135], v[220:223], v[72:75]
v_mfma_f32_16x16x32_bf16 v[92:95], a[132:135], v[224:227], v[92:95]
v_mfma_f32_16x16x32_bf16 v[112:115], a[132:135], v[228:231], v[112:115]
v_mfma_f32_16x16x32_bf16 v[56:59], a[136:139], v[216:219], v[56:59]
v_mfma_f32_16x16x32_bf16 v[76:79], a[136:139], v[220:223], v[76:79]
v_mfma_f32_16x16x32_bf16 v[96:99], a[136:139], v[224:227], v[96:99]
v_mfma_f32_16x16x32_bf16 v[116:119], a[136:139], v[228:231], v[116:119]
s_waitcnt vmcnt(24)
v_mfma_f32_16x16x32_bf16 v[40:43], a[140:143], v[232:235], v[40:43]
v_mfma_f32_16x16x32_bf16 v[60:63], a[140:143], v[236:239], v[60:63]
v_mfma_f32_16x16x32_bf16 v[80:83], a[140:143], v[240:243], v[80:83]
v_mfma_f32_16x16x32_bf16 v[100:103], a[140:143], v[244:247], v[100:103]
v_mfma_f32_16x16x32_bf16 v[44:47], a[144:147], v[232:235], v[44:47]
v_mfma_f32_16x16x32_bf16 v[64:67], a[144:147], v[236:239], v[64:67]
v_mfma_f32_16x16x32_bf16 v[84:87], a[144:147], v[240:243], v[84:87]
v_mfma_f32_16x16x32_bf16 v[104:107], a[144:147], v[244:247], v[104:107]
v_mfma_f32_16x16x32_bf16 v[48:51], a[148:151], v[232:235], v[48:51]
v_mfma_f32_16x16x32_bf16 v[68:71], a[148:151], v[236:239], v[68:71]
v_mfma_f32_16x16x32_bf16 v[88:91], a[148:151], v[240:243], v[88:91]
v_mfma_f32_16x16x32_bf16 v[108:111], a[148:151], v[244:247], v[108:111]
v_mfma_f32_16x16x32_bf16 v[52:55], a[152:155], v[232:235], v[52:55]
v_mfma_f32_16x16x32_bf16 v[72:75], a[152:155], v[236:239], v[72:75]
v_mfma_f32_16x16x32_bf16 v[92:95], a[152:155], v[240:243], v[92:95]
v_mfma_f32_16x16x32_bf16 v[112:115], a[152:155], v[244:247], v[112:115]
v_mfma_f32_16x16x32_bf16 v[56:59], a[156:159], v[232:235], v[56:59]
v_mfma_f32_16x16x32_bf16 v[76:79], a[156:159], v[236:239], v[76:79]
v_mfma_f32_16x16x32_bf16 v[96:99], a[156:159], v[240:243], v[96:99]
v_mfma_f32_16x16x32_bf16 v[116:119], a[156:159], v[244:247], v[116:119]
s_mov_b32 s12, s36
s_mov_b32 s13, s37
s_mov_b32 s14, 2621440
s_waitcnt vmcnt(20)
v_mfma_f32_16x16x32_bf16 v[40:43], a[160:163], v[120:123], v[40:43]
v_mfma_f32_16x16x32_bf16 v[60:63], a[160:163], v[124:127], v[60:63]
buffer_load_dwordx2 v[232:233], v13, s[12:15], s31 offen offset:0
v_mfma_f32_16x16x32_bf16 v[80:83], a[160:163], v[128:131], v[80:83]
buffer_load_dwordx2 v[234:235], v13, s[12:15], s31 offen offset:32
v_mfma_f32_16x16x32_bf16 v[100:103], a[160:163], v[132:135], v[100:103]
buffer_load_dwordx2 v[236:237], v13, s[12:15], s31 offen offset:64
v_mfma_f32_16x16x32_bf16 v[44:47], a[164:167], v[120:123], v[44:47]
buffer_load_dwordx2 v[238:239], v13, s[12:15], s31 offen offset:96
v_mfma_f32_16x16x32_bf16 v[64:67], a[164:167], v[124:127], v[64:67]
buffer_load_dwordx2 v[240:241], v13, s[12:15], s31 offen offset:128
v_mfma_f32_16x16x32_bf16 v[84:87], a[164:167], v[128:131], v[84:87]
v_mfma_f32_16x16x32_bf16 v[104:107], a[164:167], v[132:135], v[104:107]
v_mfma_f32_16x16x32_bf16 v[48:51], a[168:171], v[120:123], v[48:51]
v_mfma_f32_16x16x32_bf16 v[68:71], a[168:171], v[124:127], v[68:71]
v_mfma_f32_16x16x32_bf16 v[88:91], a[168:171], v[128:131], v[88:91]
v_mfma_f32_16x16x32_bf16 v[108:111], a[168:171], v[132:135], v[108:111]
v_mfma_f32_16x16x32_bf16 v[52:55], a[172:175], v[120:123], v[52:55]
v_mfma_f32_16x16x32_bf16 v[72:75], a[172:175], v[124:127], v[72:75]
v_mfma_f32_16x16x32_bf16 v[92:95], a[172:175], v[128:131], v[92:95]
v_mfma_f32_16x16x32_bf16 v[112:115], a[172:175], v[132:135], v[112:115]
v_mfma_f32_16x16x32_bf16 v[56:59], a[176:179], v[120:123], v[56:59]
v_mfma_f32_16x16x32_bf16 v[76:79], a[176:179], v[124:127], v[76:79]
v_mfma_f32_16x16x32_bf16 v[96:99], a[176:179], v[128:131], v[96:99]
v_mfma_f32_16x16x32_bf16 v[116:119], a[176:179], v[132:135], v[116:119]
s_waitcnt vmcnt(21)
v_mfma_f32_16x16x32_bf16 v[40:43], a[180:183], v[136:139], v[40:43]
v_mfma_f32_16x16x32_bf16 v[60:63], a[180:183], v[140:143], v[60:63]
v_mov_b32 v7, 336
v_mul_u32_u24 v5, v7, v1
v_mfma_f32_16x16x32_bf16 v[80:83], a[180:183], v[144:147], v[80:83]
v_lshl_add_u32 v5, v2, 4, v5
v_mfma_f32_16x16x32_bf16 v[100:103], a[180:183], v[148:151], v[100:103]
s_add_u32 s56, s24, 1
s_and_b32 s56, s56, 3
s_mul_i32 s56, s56, 3
s_add_u32 s56, s56, 0
s_mul_i32 s56, s56, 5376
v_add_u32 v9, s56, v5
v_mfma_f32_16x16x32_bf16 v[44:47], a[184:187], v[136:139], v[44:47]
s_add_u32 s56, s24, 2
s_and_b32 s56, s56, 3
s_mul_i32 s56, s56, 3
s_add_u32 s56, s56, 1
s_mul_i32 s56, s56, 5376
v_add_u32 v10, s56, v5
v_mfma_f32_16x16x32_bf16 v[64:67], a[184:187], v[140:143], v[64:67]
s_add_u32 s56, s24, 3
s_and_b32 s56, s56, 3
s_mul_i32 s56, s56, 3
s_add_u32 s56, s56, 2
s_mul_i32 s56, s56, 5376
v_add_u32 v11, s56, v5
v_mfma_f32_16x16x32_bf16 v[84:87], a[184:187], v[144:147], v[84:87]
s_mul_i32 s56, s24, 16128
v_add_u32 v14, s56, v5
v_mfma_f32_16x16x32_bf16 v[104:107], a[184:187], v[148:151], v[104:107]
s_mul_i32 s57, s24, 7168
s_add_u32 s57, s57, 102400
v_lshl_add_u32 v3, v0, 4, s57
v_mfma_f32_16x16x32_bf16 v[48:51], a[188:191], v[136:139], v[48:51]
v_mfma_f32_16x16x32_bf16 v[68:71], a[188:191], v[140:143], v[68:71]
v_mfma_f32_16x16x32_bf16 v[88:91], a[188:191], v[144:147], v[88:91]
v_mfma_f32_16x16x32_bf16 v[108:111], a[188:191], v[148:151], v[108:111]
v_mfma_f32_16x16x32_bf16 v[52:55], a[192:195], v[136:139], v[52:55]
v_mfma_f32_16x16x32_bf16 v[72:75], a[192:195], v[140:143], v[72:75]
v_mfma_f32_16x16x32_bf16 v[92:95], a[192:195], v[144:147], v[92:95]
v_mfma_f32_16x16x32_bf16 v[112:115], a[192:195], v[148:151], v[112:115]
v_mfma_f32_16x16x32_bf16 v[56:59], a[196:199], v[136:139], v[56:59]
v_mfma_f32_16x16x32_bf16 v[76:79], a[196:199], v[140:143], v[76:79]
v_mfma_f32_16x16x32_bf16 v[96:99], a[196:199], v[144:147], v[96:99]
v_mfma_f32_16x16x32_bf16 v[116:119], a[196:199], v[148:151], v[116:119]
s_waitcnt vmcnt(17)
s_cmp_lg_u32 s92, 0
s_cbranch_scc1 K2_noepb
s_mov_b32 s56, 11534336
v_lshl_add_u32 v5, v0, 4, s56
global_load_dword v242, v5, s[86:87] offset:0 sc1
global_load_dword v243, v5, s[86:87] offset:1024 sc1
global_load_dword v244, v5, s[86:87] offset:2048 sc1
global_load_dword v245, v5, s[86:87] offset:3072 sc1
global_load_dword v246, v15, s[86:87] sc1
K2_noepb:
v_mfma_f32_16x16x32_bf16 v[40:43], a[200:203], v[152:155], v[40:43]
v_mfma_f32_16x16x32_bf16 v[60:63], a[200:203], v[156:159], v[60:63]
v_mfma_f32_16x16x32_bf16 v[80:83], a[200:203], v[160:163], v[80:83]
v_mfma_f32_16x16x32_bf16 v[100:103], a[200:203], v[164:167], v[100:103]
v_mfma_f32_16x16x32_bf16 v[44:47], a[204:207], v[152:155], v[44:47]
v_mfma_f32_16x16x32_bf16 v[64:67], a[204:207], v[156:159], v[64:67]
v_mfma_f32_16x16x32_bf16 v[84:87], a[204:207], v[160:163], v[84:87]
v_mfma_f32_16x16x32_bf16 v[104:107], a[204:207], v[164:167], v[104:107]
v_mfma_f32_16x16x32_bf16 v[48:51], a[208:211], v[152:155], v[48:51]
v_mfma_f32_16x16x32_bf16 v[68:71], a[208:211], v[156:159], v[68:71]
v_mfma_f32_16x16x32_bf16 v[88:91], a[208:211], v[160:163], v[88:91]
v_mfma_f32_16x16x32_bf16 v[108:111], a[208:211], v[164:167], v[108:111]
v_mfma_f32_16x16x32_bf16 v[52:55], a[212:215], v[152:155], v[52:55]
v_mfma_f32_16x16x32_bf16 v[72:75], a[212:215], v[156:159], v[72:75]
v_mfma_f32_16x16x32_bf16 v[92:95], a[212:215], v[160:163], v[92:95]
v_mfma_f32_16x16x32_bf16 v[112:115], a[212:215], v[164:167], v[112:115]
v_mfma_f32_16x16x32_bf16 v[56:59], a[216:219], v[152:155], v[56:59]
v_mfma_f32_16x16x32_bf16 v[76:79], a[216:219], v[156:159], v[76:79]
v_mfma_f32_16x16x32_bf16 v[96:99], a[216:219], v[160:163], v[96:99]
v_mfma_f32_16x16x32_bf16 v[116:119], a[216:219], v[164:167], v[116:119]
s_waitcnt vmcnt(12)
v_mfma_f32_16x16x32_bf16 v[60:63], a[220:223], v[172:175], v[60:63]
v_mfma_f32_16x16x32_bf16 v[64:67], a[224:227], v[172:175], v[64:67]
v_mfma_f32_16x16x32_bf16 v[68:71], a[228:231], v[172:175], v[68:71]
v_mfma_f32_16x16x32_bf16 v[72:75], a[232:235], v[172:175], v[72:75]
v_mfma_f32_16x16x32_bf16 v[76:79], a[236:239], v[172:175], v[76:79]
v_mfma_f32_16x16x32_bf16 v[80:83], a[220:223], v[176:179], v[80:83]
v_mfma_f32_16x16x32_bf16 v[84:87], a[224:227], v[176:179], v[84:87]
v_mfma_f32_16x16x32_bf16 v[88:91], a[228:231], v[176:179], v[88:91]
v_mfma_f32_16x16x32_bf16 v[92:95], a[232:235], v[176:179], v[92:95]
v_mfma_f32_16x16x32_bf16 v[96:99], a[236:239], v[176:179], v[96:99]
v_mfma_f32_16x16x32_bf16 v[100:103], a[220:223], v[180:183], v[100:103]
ds_write_b128 v9, v[60:63] offset:0
v_mfma_f32_16x16x32_bf16 v[104:107], a[224:227], v[180:183], v[104:107]
ds_write_b128 v9, v[64:67] offset:64
v_mfma_f32_16x16x32_bf16 v[108:111], a[228:231], v[180:183], v[108:111]
ds_write_b128 v9, v[68:71] offset:128
v_mfma_f32_16x16x32_bf16 v[112:115], a[232:235], v[180:183], v[112:115]
ds_write_b128 v9, v[72:75] offset:192
v_mfma_f32_16x16x32_bf16 v[116:119], a[236:239], v[180:183], v[116:119]
ds_write_b128 v9, v[76:79] offset:256
v_mfma_f32_16x16x32_bf16 v[40:43], a[220:223], v[168:171], v[40:43]
ds_write_b128 v10, v[80:83] offset:0
v_mfma_f32_16x16x32_bf16 v[44:47], a[224:227], v[168:171], v[44:47]
ds_write_b128 v10, v[84:87] offset:64
v_mfma_f32_16x16x32_bf16 v[48:51], a[228:231], v[168:171], v[48:51]
ds_write_b128 v10, v[88:91] offset:128
v_mfma_f32_16x16x32_bf16 v[52:55], a[232:235], v[168:171], v[52:55]
ds_write_b128 v10, v[92:95] offset:192
v_mfma_f32_16x16x32_bf16 v[56:59], a[236:239], v[168:171], v[56:59]
ds_write_b128 v10, v[96:99] offset:256
ds_write_b128 v11, v[100:103] offset:0
ds_write_b128 v11, v[104:107] offset:64
ds_write_b128 v11, v[108:111] offset:128
ds_write_b128 v11, v[112:115] offset:192
ds_write_b128 v11, v[116:119] offset:256
s_waitcnt lgkmcnt(0)
s_barrier
ds_read_b128 v[120:123], v14 offset:0
ds_read_b128 v[124:127], v14 offset:64
ds_read_b128 v[128:131], v14 offset:128
ds_read_b128 v[132:135], v14 offset:192
ds_read_b128 v[136:139], v14 offset:256
ds_read_b128 v[140:143], v14 offset:5376
ds_read_b128 v[144:147], v14 offset:5440
ds_read_b128 v[148:151], v14 offset:5504
ds_read_b128 v[152:155], v14 offset:5568
ds_read_b128 v[156:159], v14 offset:5632
ds_read_b128 v[160:163], v14 offset:10752
ds_read_b128 v[164:167], v14 offset:10816
ds_read_b128 v[168:171], v14 offset:10880
ds_read_b128 v[172:175], v14 offset:10944
ds_read_b128 v[176:179], v14 offset:11008
v_mov_b32 v6, 0xbf317218
v_mov_b32 v7, 0xbf317218
s_waitcnt lgkmcnt(5)
v_pk_add_f32 v[40:41], v[40:41], v[120:121]
v_pk_add_f32 v[42:43], v[42:43], v[122:123]
v_pk_add_f32 v[44:45], v[44:45], v[124:125]
v_pk_add_f32 v[46:47], v[46:47], v[126:127]
v_pk_add_f32 v[48:49], v[48:49], v[128:129]
v_pk_add_f32 v[50:51], v[50:51], v[130:131]
v_pk_add_f32 v[52:53], v[52:53], v[132:133]
v_pk_add_f32 v[54:55], v[54:55], v[134:135]
v_pk_add_f32 v[56:57], v[56:57], v[136:137]
v_pk_add_f32 v[58:59], v[58:59], v[138:139]
v_pk_add_f32 v[40:41], v[40:41], v[140:141]
v_pk_add_f32 v[42:43], v[42:43], v[142:143]
v_pk_add_f32 v[44:45], v[44:45], v[144:145]
v_pk_add_f32 v[46:47], v[46:47], v[146:147]
v_pk_add_f32 v[48:49], v[48:49], v[148:149]
v_pk_add_f32 v[50:51], v[50:51], v[150:151]
v_pk_add_f32 v[52:53], v[52:53], v[152:153]
v_pk_add_f32 v[54:55], v[54:55], v[154:155]
v_pk_add_f32 v[56:57], v[56:57], v[156:157]
v_pk_add_f32 v[58:59], v[58:59], v[158:159]
s_waitcnt lgkmcnt(0)
v_pk_add_f32 v[40:41], v[40:41], v[160:161]
v_pk_add_f32 v[42:43], v[42:43], v[162:163]
v_pk_add_f32 v[44:45], v[44:45], v[164:165]
v_pk_add_f32 v[46:47], v[46:47], v[166:167]
v_pk_add_f32 v[48:49], v[48:49], v[168:169]
v_pk_add_f32 v[50:51], v[50:51], v[170:171]
v_pk_add_f32 v[52:53], v[52:53], v[172:173]
v_pk_add_f32 v[54:55], v[54:55], v[174:175]
v_pk_add_f32 v[56:57], v[56:57], v[176:177]
v_pk_add_f32 v[58:59], v[58:59], v[178:179]
v_exp_f32 v60, v40
v_exp_f32 v61, v41
v_exp_f32 v62, v42
v_exp_f32 v63, v43
v_exp_f32 v64, v44
v_exp_f32 v65, v45
v_exp_f32 v66, v46
v_exp_f32 v67, v47
v_exp_f32 v68, v48
v_exp_f32 v69, v49
v_exp_f32 v70, v50
v_exp_f32 v71, v51
v_exp_f32 v72, v52
v_exp_f32 v73, v53
v_exp_f32 v74, v54
v_exp_f32 v75, v55
v_exp_f32 v76, v56
v_exp_f32 v77, v57
v_exp_f32 v78, v58
v_exp_f32 v79, v59
v_pk_add_f32 v[60:61], v[60:61], 1.0 op_sel_hi:[1,0]
v_pk_add_f32 v[62:63], v[62:63], 1.0 op_sel_hi:[1,0]
v_pk_mul_f32 v[40:41], v[40:41], v[6:7]
v_pk_mul_f32 v[42:43], v[42:43], v[6:7]
v_pk_add_f32 v[64:65], v[64:65], 1.0 op_sel_hi:[1,0]
v_pk_add_f32 v[66:67], v[66:67], 1.0 op_sel_hi:[1,0]
v_pk_mul_f32 v[44:45], v[44:45], v[6:7]
v_pk_mul_f32 v[46:47], v[46:47], v[6:7]
v_pk_add_f32 v[68:69], v[68:69], 1.0 op_sel_hi:[1,0]
v_pk_add_f32 v[70:71], v[70:71], 1.0 op_sel_hi:[1,0]
v_pk_mul_f32 v[48:49], v[48:49], v[6:7]
v_pk_mul_f32 v[50:51], v[50:51], v[6:7]
v_pk_add_f32 v[72:73], v[72:73], 1.0 op_sel_hi:[1,0]
v_pk_add_f32 v[74:75], v[74:75], 1.0 op_sel_hi:[1,0]
v_pk_mul_f32 v[52:53], v[52:53], v[6:7]
v_pk_mul_f32 v[54:55], v[54:55], v[6:7]
v_pk_add_f32 v[76:77], v[76:77], 1.0 op_sel_hi:[1,0]
v_pk_add_f32 v[78:79], v[78:79], 1.0 op_sel_hi:[1,0]
v_pk_mul_f32 v[56:57], v[56:57], v[6:7]
v_pk_mul_f32 v[58:59], v[58:59], v[6:7]
v_rcp_f32 v60, v60
v_rcp_f32 v61, v61
v_rcp_f32 v62, v62
v_rcp_f32 v63, v63
v_rcp_f32 v64, v64
v_rcp_f32 v65, v65
v_rcp_f32 v66, v66
v_rcp_f32 v67, v67
v_rcp_f32 v68, v68
v_rcp_f32 v69, v69
v_rcp_f32 v70, v70
v_rcp_f32 v71, v71
v_rcp_f32 v72, v72
v_rcp_f32 v73, v73
v_rcp_f32 v74, v74
v_rcp_f32 v75, v75
v_rcp_f32 v76, v76
v_rcp_f32 v77, v77
v_rcp_f32 v78, v78
v_rcp_f32 v79, v79
s_nop 0
v_pk_mul_f32 v[40:41], v[40:41], v[60:61]
v_pk_mul_f32 v[42:43], v[42:43], v[62:63]
v_pk_mul_f32 v[44:45], v[44:45], v[64:65]
v_pk_mul_f32 v[46:47], v[46:47], v[66:67]
v_pk_mul_f32 v[48:49], v[48:49], v[68:69]
v_pk_mul_f32 v[50:51], v[50:51], v[70:71]
v_pk_mul_f32 v[52:53], v[52:53], v[72:73]
v_pk_mul_f32 v[54:55], v[54:55], v[74:75]
v_pk_mul_f32 v[56:57], v[56:57], v[76:77]
v_pk_mul_f32 v[58:59], v[58:59], v[78:79]
s_waitcnt vmcnt(5)
K2_join:
v_xor_b32 v18, s33, v18
v_xor_b32 v19, s33, v19
ds_write_b128 v3, v[16:19] offset:0
v_xor_b32 v22, s33, v22
v_xor_b32 v23, s33, v23
ds_write_b128 v3, v[20:23] offset:1024
v_xor_b32 v26, s33, v26
v_xor_b32 v27, s33, v27
ds_write_b128 v3, v[24:27] offset:2048
v_xor_b32 v30, s33, v30
v_xor_b32 v31, s33, v31
ds_write_b128 v3, v[28:31] offset:3072
v_xor_b32 v34, s33, v34
v_xor_b32 v35, s33, v35
ds_write_b128 v3, v[32:35] offset:4096
v_xor_b32 v38, s33, v38
v_xor_b32 v39, s33, v39
ds_write_b128 v3, v[36:39] offset:5120
v_xor_b32 v250, s33, v250
v_xor_b32 v251, s33, v251
ds_write_b128 v3, v[248:251] offset:6144
s_waitcnt lgkmcnt(0)
s_barrier
ds_read_b64_tr_b16 v[120:121], v12 offset:0
ds_read_b64_tr_b16 v[122:123], v12 offset:1792
ds_read_b64_tr_b16 v[124:125], v12 offset:64
ds_read_b64_tr_b16 v[126:127], v12 offset:1856
ds_read_b64_tr_b16 v[128:129], v12 offset:128
ds_read_b64_tr_b16 v[130:131], v12 offset:1920
ds_read_b64_tr_b16 v[132:133], v12 offset:192
ds_read_b64_tr_b16 v[134:135], v12 offset:1984
ds_read_b64_tr_b16 v[136:137], v12 offset:256
ds_read_b64_tr_b16 v[138:139], v12 offset:2048
ds_read_b64_tr_b16 v[140:141], v12 offset:320
ds_read_b64_tr_b16 v[142:143], v12 offset:2112
ds_read_b64_tr_b16 v[144:145], v12 offset:7168
ds_read_b64_tr_b16 v[146:147], v12 offset:8960
ds_read_b64_tr_b16 v[148:149], v12 offset:7232
ds_read_b64_tr_b16 v[150:151], v12 offset:9024
ds_read_b64_tr_b16 v[152:153], v12 offset:7296
ds_read_b64_tr_b16 v[154:155], v12 offset:9088
ds_read_b64_tr_b16 v[156:157], v12 offset:7360
ds_read_b64_tr_b16 v[158:159], v12 offset:9152
ds_read_b64_tr_b16 v[160:161], v12 offset:7424
ds_read_b64_tr_b16 v[162:163], v12 offset:9216
ds_read_b64_tr_b16 v[164:165], v12 offset:7488
ds_read_b64_tr_b16 v[166:167], v12 offset:9280
s_waitcnt vmcnt(0)
v_lshlrev_b32 v80, 16, v232
v_and_b32 v81, 0xffff0000, v232
v_lshlrev_b32 v82, 16, v233
v_and_b32 v83, 0xffff0000, v233
v_lshlrev_b32 v84, 16, v234
v_and_b32 v85, 0xffff0000, v234
v_lshlrev_b32 v86, 16, v235
v_and_b32 v87, 0xffff0000, v235
v_lshlrev_b32 v88, 16, v236
v_and_b32 v89, 0xffff0000, v236
s_waitcnt lgkmcnt(12)
v_mfma_f32_16x16x32_bf16 v[16:19], v[120:123], a[240:243], 0
ds_read_b64_tr_b16 v[168:169], v12 offset:14336
ds_read_b64_tr_b16 v[170:171], v12 offset:16128
v_mfma_f32_16x16x32_bf16 v[20:23], v[124:127], a[240:243], 0
ds_read_b64_tr_b16 v[172:173], v12 offset:14400
ds_read_b64_tr_b16 v[174:175], v12 offset:16192
v_mfma_f32_16x16x32_bf16 v[24:27], v[128:131], a[240:243], 0
ds_read_b64_tr_b16 v[176:177], v12 offset:14464
ds_read_b64_tr_b16 v[178:179], v12 offset:16256
v_mfma_f32_16x16x32_bf16 v[28:31], v[132:135], a[240:243], 0
ds_read_b64_tr_b16 v[180:181], v12 offset:14528
ds_read_b64_tr_b16 v[182:183], v12 offset:16320
v_mfma_f32_16x16x32_bf16 v[32:35], v[136:139], a[240:243], 0
ds_read_b64_tr_b16 v[184:185], v12 offset:14592
ds_read_b64_tr_b16 v[186:187], v12 offset:16384
v_mfma_f32_16x16x32_bf16 v[36:39], v[140:143], a[240:243], 0
ds_read_b64_tr_b16 v[188:189], v12 offset:14656
ds_read_b64_tr_b16 v[190:191], v12 offset:16448
v_lshlrev_b32 v90, 16, v237
v_and_b32 v91, 0xffff0000, v237
v_lshlrev_b32 v92, 16, v238
v_and_b32 v93, 0xffff0000, v238
v_lshlrev_b32 v94, 16, v239
v_and_b32 v95, 0xffff0000, v239
v_lshlrev_b32 v96, 16, v240
v_and_b32 v97, 0xffff0000, v240
v_lshlrev_b32 v98, 16, v241
v_and_b32 v99, 0xffff0000, v241
s_waitcnt lgkmcnt(12)
v_mfma_f32_16x16x32_bf16 v[16:19], v[144:147], a[244:247], v[16:19]
ds_read_b64_tr_b16 v[192:193], v12 offset:21504
ds_read_b64_tr_b16 v[194:195], v12 offset:23296
v_mfma_f32_16x16x32_bf16 v[20:23], v[148:151], a[244:247], v[20:23]
ds_read_b64_tr_b16 v[196:197], v12 offset:21568
ds_read_b64_tr_b16 v[198:199], v12 offset:23360
v_mfma_f32_16x16x32_bf16 v[24:27], v[152:155], a[244:247], v[24:27]
ds_read_b64_tr_b16 v[200:201], v12 offset:21632
ds_read_b64_tr_b16 v[202:203], v12 offset:23424
v_mfma_f32_16x16x32_bf16 v[28:31], v[156:159], a[244:247], v[28:31]
ds_read_b64_tr_b16 v[204:205], v12 offset:21696
ds_read_b64_tr_b16 v[206:207], v12 offset:23488
v_mfma_f32_16x16x32_bf16 v[32:35], v[160:163], a[244:247], v[32:35]
ds_read_b64_tr_b16 v[208:209], v12 offset:21760
ds_read_b64_tr_b16 v[210:211], v12 offset:23552
v_mfma_f32_16x16x32_bf16 v[36:39], v[164:167], a[244:247], v[36:39]
ds_read_b64_tr_b16 v[212:213], v12 offset:21824
ds_read_b64_tr_b16 v[214:215], v12 offset:23616
s_mul_i32 s56, s24, 7424
s_add_u32 s56, s56, 131072
v_mov_b32 v7, 464
v_mul_u32_u24 v5, v7, v1
v_add_u32 v5, s56, v5
v_lshlrev_b32 v6, 4, v2
v_sub_u32 v7, v5, v6
v_add_u32 v7, 52, v7
v_add_u32 v5, v5, v6
s_waitcnt lgkmcnt(12)
v_mfma_f32_16x16x32_bf16 v[16:19], v[168:171], a[248:251], v[16:19]
v_mfma_f32_16x16x32_bf16 v[20:23], v[172:175], a[248:251], v[20:23]
v_mfma_f32_16x16x32_bf16 v[24:27], v[176:179], a[248:251], v[24:27]
v_mfma_f32_16x16x32_bf16 v[28:31], v[180:183], a[248:251], v[28:31]
v_mfma_f32_16x16x32_bf16 v[32:35], v[184:187], a[248:251], v[32:35]
v_mfma_f32_16x16x32_bf16 v[36:39], v[188:191], a[248:251], v[36:39]
s_waitcnt lgkmcnt(0)
v_mfma_f32_16x16x32_bf16 v[16:19], v[192:195], a[252:255], v[16:19]
v_mfma_f32_16x16x32_bf16 v[20:23], v[196:199], a[252:255], v[20:23]
v_mfma_f32_16x16x32_bf16 v[24:27], v[200:203], a[252:255], v[24:27]
v_mfma_f32_16x16x32_bf16 v[28:31], v[204:207], a[252:255], v[28:31]
v_mfma_f32_16x16x32_bf16 v[32:35], v[208:211], a[252:255], v[32:35]
v_mfma_f32_16x16x32_bf16 v[36:39], v[212:215], a[252:255], v[36:39]
s_nop 7
s_nop 1
s_cmp_eq_u32 s27, 0
s_cbranch_scc1 K2_direct
ds_write2_b32 v7, v16, v17 offset0:83 offset1:82
ds_write2_b32 v7, v18, v19 offset0:81 offset1:80
ds_write2_b32 v7, v20, v21 offset0:67 offset1:66
ds_write2_b32 v7, v22, v23 offset0:65 offset1:64
ds_write2_b32 v7, v24, v25 offset0:51 offset1:50
ds_write2_b32 v7, v26, v27 offset0:49 offset1:48
ds_write2_b32 v7, v28, v29 offset0:35 offset1:34
ds_write2_b32 v7, v30, v31 offset0:33 offset1:32
ds_write2_b32 v7, v32, v33 offset0:19 offset1:18
ds_write2_b32 v7, v34, v35 offset0:17 offset1:16
ds_write2_b32 v7, v36, v37 offset0:3 offset1:2
ds_write2_b32 v7, v38, v39 offset0:1 offset1:0
s_waitcnt lgkmcnt(0)
ds_read_b128 v[16:19], v5 offset:64
ds_read_b128 v[20:23], v5 offset:128
ds_read_b128 v[24:27], v5 offset:192
ds_read_b128 v[28:31], v5 offset:256
ds_read_b128 v[32:35], v5 offset:320
s_waitcnt lgkmcnt(0)
s_branch K2_ydone
K2_direct:
s_cmp_eq_u32 s91, 0
s_cselect_b64 s[58:59], -1, 0
v_cmp_eq_u32 vcc, 0, v2
s_and_b64 vcc, vcc, s[58:59]
s_nop 1
v_cndmask_b32_e64 v16, v16, 0, vcc
K2_ydone:
v_pk_fma_f32 v[80:81], v[40:41], v[16:17], v[80:81]
v_pk_fma_f32 v[82:83], v[42:43], v[18:19], v[82:83]
v_cvt_pk_bf16_f32 v100, v80, v81
v_cvt_pk_bf16_f32 v101, v82, v83
buffer_store_dwordx2 v[100:101], v13, s[20:23], s31 offen offset:0
v_pk_fma_f32 v[84:85], v[44:45], v[20:21], v[84:85]
v_pk_fma_f32 v[86:87], v[46:47], v[22:23], v[86:87]
v_cvt_pk_bf16_f32 v102, v84, v85
v_cvt_pk_bf16_f32 v103, v86, v87
buffer_store_dwordx2 v[102:103], v13, s[20:23], s31 offen offset:32
v_pk_fma_f32 v[88:89], v[48:49], v[24:25], v[88:89]
v_pk_fma_f32 v[90:91], v[50:51], v[26:27], v[90:91]
v_cvt_pk_bf16_f32 v104, v88, v89
v_cvt_pk_bf16_f32 v105, v90, v91
buffer_store_dwordx2 v[104:105], v13, s[20:23], s31 offen offset:64
v_pk_fma_f32 v[92:93], v[52:53], v[28:29], v[92:93]
v_pk_fma_f32 v[94:95], v[54:55], v[30:31], v[94:95]
v_cvt_pk_bf16_f32 v106, v92, v93
v_cvt_pk_bf16_f32 v107, v94, v95
buffer_store_dwordx2 v[106:107], v13, s[20:23], s31 offen offset:96
v_pk_fma_f32 v[96:97], v[56:57], v[32:33], v[96:97]
v_pk_fma_f32 v[98:99], v[58:59], v[34:35], v[98:99]
v_cvt_pk_bf16_f32 v108, v96, v97
v_cvt_pk_bf16_f32 v109, v98, v99
buffer_store_dwordx2 v[108:109], v13, s[20:23], s31 offen offset:128
s_cmp_lg_u32 s92, 0
s_cbranch_scc1 K2_fin
s_mov_b32 s62, 0
K2_ep:
s_waitcnt vmcnt(0)
s_mov_b64 exec, 0x3f3f3f3f
s_mov_b32 exec_hi, 0x3f3f3f3f
v_cmp_ne_u32 s[56:57], s65, v242
v_cmp_ne_u32 s[58:59], s65, v243
v_cmp_ne_u32 vcc, s65, v244
s_nop 1
s_or_b64 s[56:57], s[56:57], s[58:59]
s_or_b64 s[56:57], s[56:57], vcc
v_cmp_ne_u32 vcc, s65, v245
s_nop 1
s_or_b64 s[56:57], s[56:57], vcc
s_mov_b64 exec, -1
v_cmp_ne_u32 vcc, s65, v246
s_nop 1
s_or_b64 s[56:57], s[56:57], vcc
s_cmp_eq_u64 s[56:57], 0
s_cbranch_scc1 K2_epd
s_add_u32 s62, s62, 1
s_cmp_ge_u32 s62, 200000
s_cbranch_scc1 K2_epd
s_mov_b32 s56, 11534336
v_lshl_add_u32 v5, v0, 4, s56
global_load_dword v242, v5, s[86:87] offset:0 sc1
global_load_dword v243, v5, s[86:87] offset:1024 sc1
global_load_dword v244, v5, s[86:87] offset:2048 sc1
global_load_dword v245, v5, s[86:87] offset:3072 sc1
global_load_dword v246, v15, s[86:87] sc1
s_branch K2_ep
K2_epd:
v_mov_b32 v5, 11550720
v_mov_b32 v6, s65
s_mov_b64 exec, 1
global_store_dword v5, v6, s[86:87] sc1
K2_fin:
F_end:
s_endpgm
K1_g1:
s_mul_i32 s26, s59, 6
s_add_u32 s26, s26, s58
s_sub_u32 s26, s26, 2
v_xor_b32 v5, v4, v2
v_lshlrev_b32 v5, 4, v5
v_mov_b32 v7, 81920
v_mul_u32_u24 v6, v7, v3
v_add3_u32 v6, v6, v5, s61
v_mov_b32 v8, v6
v_xor_b32 v7, 64, v6
v_add_u32 v9, 654336, v7
v_add_u32 v10, 1308672, v6
v_add_u32 v11, 1963008, v7
s_lshl_b32 s62, s24, 4
v_add_u32 v5, s62, v2
v_mul_u32_u24 v5, 3072, v5
v_lshlrev_b32 v6, 1, v2
v_xor_b32 v6, v6, v1
v_lshlrev_b32 v6, 4, v6
s_lshl_b32 s62, s26, 8
v_add3_u32 v5, v5, v6, s62
v_mov_b32 v12, v5
v_xor_b32 v6, 128, v5
v_add_u32 v13, 23552, v6
v_add_u32 v14, 10240, v5
v_add_u32 v15, 33792, v6
s_mul_i32 s56, s3, 2185
s_lshr_b32 s56, s56, 16
s_mul_i32 s57, s56, 30
s_sub_u32 s57, s3, s57
s_lshl_b32 s93, s56, 9
s_lshl_b32 s62, s57, 4
s_add_u32 s93, s93, s62
s_add_u32 s93, s93, 11542528
s_lshl_b32 s57, s57, 2
s_add_u32 s57, s57, s24
s_mul_i32 s62, s57, 13108
s_lshr_b32 s62, s62, 16
s_mul_i32 s63, s62, 5
s_sub_u32 s63, s57, s63
s_mul_i32 s95, s62, 81920
s_mul_i32 s57, s56, 320
s_add_u32 s95, s95, s57
s_lshl_b32 s57, s63, 6
s_add_u32 s95, s95, s57
s_mul_i32 s56, s56, 491520
s_mul_i32 s62, s62, 10240
s_add_u32 s56, s56, s62
s_lshl_b32 s63, s63, 11
s_add_u32 s57, s63, 240640
s_cmp_ge_u32 s63, 5120
s_cselect_b32 s98, s57, s63
s_add_u32 s98, s98, s56
s_add_u32 s63, s63, 1024
s_add_u32 s57, s63, 240640
s_cmp_ge_u32 s63, 5120
s_cselect_b32 s99, s57, s63
s_add_u32 s99, s99, s56
v_lshrrev_b32 v5, 2, v0
v_and_b32 v6, 3, v0
v_mul_u32_u24 v7, 1280, v5
v_lshl_add_u32 v220, v6, 4, v7
s_cmp_lt_u32 s3, 120
s_cselect_b32 s92, 2, 99
s_cmp_eq_u32 s24, 0
s_cselect_b32 s92, s92, 99
s_waitcnt lgkmcnt(0)
global_load_dword v26, v27, s[86:87] sc1
s_mov_b32 s4, s36
s_mov_b32 s5, s37
s_mov_b32 s8, s48
s_mov_b32 s9, s49
s_mov_b32 s10, 1966080
s_mov_b32 s16, s50
s_mov_b32 s17, s51
s_mov_b32 s18, 1966080
s_cmp_ge_u32 s3, 120
s_cbranch_scc1 G1_nopre1
buffer_load_dwordx4 v[180:183], v220, s[16:19], s95 offen
s_add_u32 s95, s95, 20480
buffer_load_dwordx4 v[184:187], v220, s[16:19], s95 offen
s_add_u32 s95, s95, 20480
buffer_load_dwordx4 v[188:191], v220, s[16:19], s95 offen
s_add_u32 s95, s95, 20480
buffer_load_dwordx4 v[192:195], v220, s[16:19], s95 offen
G1_nopre1:
s_mov_b32 s28, 0
s_mov_b32 s29, 0
s_add_u32 s35, s34, 16384
s_add_u32 m0, s34, 0
s_nop 0
buffer_load_dwordx4 v8, s[4:7], s28 offen lds
buffer_load_dwordx4 v9, s[4:7], s28 offen offset:1024 lds
buffer_load_dwordx4 v10, s[4:7], s28 offen offset:2048 lds
buffer_load_dwordx4 v11, s[4:7], s28 offen offset:3072 lds
s_add_u32 m0, s35, 0
s_nop 0
buffer_load_dwordx4 v12, s[8:11], s29 offen lds
v_lshrrev_b32 v5, 1, v1
v_xor_b32 v5, v5, v2
v_lshlrev_b32 v5, 4, v5
v_lshl_add_u32 v5, v1, 7, v5
v_add_u32 v24, s34, v5
v_xor_b32 v25, 64, v24
v_lshrrev_b32 v5, 2, v1
buffer_load_dwordx4 v13, s[8:11], s29 offen offset:1024 lds
v_and_b32 v6, 1, v2
v_lshl_add_u32 v5, v6, 2, v5
v_lshrrev_b32 v6, 1, v2
v_lshl_add_u32 v6, v6, 4, v5
v_lshlrev_b32 v6, 8, v6
v_and_b32 v7, 3, v1
v_lshl_add_u32 v6, v7, 3, v6
buffer_load_dwordx4 v14, s[8:11], s29 offen offset:2048 lds
v_add_u32 v6, 16384, v6
s_lshl_b32 s62, s24, 1
s_add_u32 s62, s62, 0
s_and_b32 s62, s62, 7
v_xor_b32 v7, s62, v5
v_lshl_add_u32 v16, v7, 5, v6
s_lshl_b32 s62, s24, 1
buffer_load_dwordx4 v15, s[8:11], s29 offen offset:3072 lds
s_add_u32 s28, s28, 128
s_add_u32 s29, s29, 196608
s_add_u32 s62, s62, 1
s_and_b32 s62, s62, 7
v_xor_b32 v7, s62, v5
v_lshl_add_u32 v17, v7, 5, v6
s_lshl_b32 s62, s24, 1
s_add_u32 s62, s62, 2
s_and_b32 s62, s62, 7
s_add_u32 m0, s34, 32768
s_nop 0
buffer_load_dwordx4 v8, s[4:7], s28 offen lds
v_xor_b32 v7, s62, v5
v_lshl_add_u32 v18, v7, 5, v6
s_lshl_b32 s62, s24, 1
s_add_u32 s62, s62, 3
s_and_b32 s62, s62, 7
v_xor_b32 v7, s62, v5
v_lshl_add_u32 v19, v7, 5, v6
buffer_load_dwordx4 v9, s[4:7], s28 offen offset:1024 lds
s_lshl_b32 s62, s24, 1
s_add_u32 s62, s62, 4
s_and_b32 s62, s62, 7
v_xor_b32 v7, s62, v5
v_lshl_add_u32 v20, v7, 5, v6
s_lshl_b32 s62, s24, 1
s_add_u32 s62, s62, 5
buffer_load_dwordx4 v10, s[4:7], s28 offen offset:2048 lds
s_and_b32 s62, s62, 7
v_xor_b32 v7, s62, v5
v_lshl_add_u32 v21, v7, 5, v6
s_lshl_b32 s62, s24, 1
s_add_u32 s62, s62, 6
s_and_b32 s62, s62, 7
v_xor_b32 v7, s62, v5
buffer_load_dwordx4 v11, s[4:7], s28 offen offset:3072 lds
v_lshl_add_u32 v22, v7, 5, v6
s_lshl_b32 s62, s24, 1
s_add_u32 s62, s62, 7
s_and_b32 s62, s62, 7
v_xor_b32 v7, s62, v5
v_lshl_add_u32 v23, v7, 5, v6
v_and_b32 v204, 3, v0
s_add_u32 m0, s35, 32768
s_nop 0
buffer_load_dwordx4 v12, s[8:11], s29 offen lds
v_cmp_eq_u32 s[50:51], 1, v204
v_cmp_eq_u32 s[52:53], 2, v204
v_cmp_eq_u32 s[54:55], 3, v204
v_and_b32 v204, 15, v0
v_lshrrev_b32 v215, 2, v204
v_lshlrev_b32 v215, 6, v215
v_lshl_add_u32 v215, v204, 2, v215
buffer_load_dwordx4 v13, s[8:11], s29 offen offset:1024 lds
v_mov_b32 v120, 0x3f803f80
v_mov_b32 v121, 0x3f803f80
v_mov_b32 v122, 0x3f803f80
v_mov_b32 v123, 0x3f803f80
v_lshlrev_b32 v254, 4, v0
s_lshr_b32 s62, s91, 1
s_lshl_b32 s62, s62, 9
buffer_load_dwordx4 v14, s[8:11], s29 offen offset:2048 lds
s_add_u32 s62, s62, 11542528
v_lshl_add_u32 v29, v0, 4, s62
s_mul_i32 s62, s24, 5120
s_add_u32 s62, s62, 131072
v_lshrrev_b32 v7, 2, v0
v_mul_u32_u24 v7, 80, v7
v_and_b32 v6, 3, v0
buffer_load_dwordx4 v15, s[8:11], s29 offen offset:3072 lds
s_add_u32 s28, s28, 128
s_add_u32 s29, s29, 196608
v_lshl_add_u32 v7, v6, 4, v7
v_add_u32 v221, s62, v7
v_lshrrev_b32 v7, 2, v1
v_lshl_add_u32 v7, v2, 2, v7
v_mul_u32_u24 v7, 80, v7
v_lshl_add_u32 v7, v6, 3, v7
v_add_u32 v222, s62, v7
s_waitcnt vmcnt(16)
s_nop 0
v_readfirstlane_b32 s65, v26
s_nop 3
s_mul_i32 s65, s65, 0x9E3779B1
s_add_u32 s65, s65, 0x7F4A7C15
s_mov_b32 s16, s86
s_mov_b32 s17, s87
s_add_u32 s16, s16, 9437184
s_addc_u32 s17, s17, 0
s_mov_b32 s18, 1966080
s_cmp_ge_u32 s3, 120
s_cbranch_scc1 G1_nopre2
ds_write_b128 v221, v[180:183] offset:0
ds_write_b128 v221, v[184:187] offset:1280
ds_write_b128 v221, v[188:191] offset:2560
ds_write_b128 v221, v[192:195] offset:3840
ds_read_b64_tr_b16 v[164:165], v222 offset:0
ds_read_b64_tr_b16 v[166:167], v222 offset:1280
ds_read_b64_tr_b16 v[168:169], v222 offset:32
ds_read_b64_tr_b16 v[170:171], v222 offset:1312
ds_read_b64_tr_b16 v[172:173], v222 offset:2560
ds_read_b64_tr_b16 v[174:175], v222 offset:3840
ds_read_b64_tr_b16 v[176:177], v222 offset:2592
ds_read_b64_tr_b16 v[178:179], v222 offset:3872
v_lshlrev_b32 v5, 4, v0
s_waitcnt lgkmcnt(0)
buffer_store_dwordx4 v[164:167], v5, s[16:19], s98 offen offset:0 sc1
buffer_store_dwordx4 v[168:171], v5, s[16:19], s99 offen offset:0 sc1
s_add_u32 s98, s98, 5120
s_add_u32 s99, s99, 5120
buffer_store_dwordx4 v[172:175], v5, s[16:19], s98 offen offset:0 sc1
buffer_store_dwordx4 v[176:179], v5, s[16:19], s99 offen offset:0 sc1
s_waitcnt vmcnt(12)
s_branch G1_pre_done
G1_nopre2:
s_waitcnt vmcnt(8)
G1_pre_done:
s_barrier
ds_read_b128 v[156:159], v24 offset:0
ds_read_b128 v[160:163], v24 offset:2048
ds_read_b64_tr_b16 v[124:125], v16 offset:0
ds_read_b64_tr_b16 v[126:127], v16 offset:2048
ds_read_b64_tr_b16 v[128:129], v17 offset:0
ds_read_b64_tr_b16 v[130:131], v17 offset:2048
ds_read_b64_tr_b16 v[132:133], v18 offset:0
ds_read_b64_tr_b16 v[134:135], v18 offset:2048
ds_read_b64_tr_b16 v[136:137], v19 offset:0
ds_read_b64_tr_b16 v[138:139], v19 offset:2048
ds_read_b64_tr_b16 v[140:141], v20 offset:0
ds_read_b64_tr_b16 v[142:143], v20 offset:2048
ds_read_b64_tr_b16 v[144:145], v21 offset:0
ds_read_b64_tr_b16 v[146:147], v21 offset:2048
ds_read_b64_tr_b16 v[148:149], v22 offset:0
ds_read_b64_tr_b16 v[150:151], v22 offset:2048
ds_read_b64_tr_b16 v[152:153], v23 offset:0
ds_read_b64_tr_b16 v[154:155], v23 offset:2048
s_waitcnt lgkmcnt(0)
v_mfma_f32_16x16x32_bf16 v[32:35], v[124:127], v[156:159], 0
ds_read_b128 v[196:199], v25 offset:0
v_mfma_f32_16x16x32_bf16 v[36:39], v[124:127], v[160:163], 0
ds_read_b128 v[200:203], v25 offset:2048
s_add_u32 m0, s34, 65536
s_nop 0
buffer_load_dwordx4 v8, s[4:7], s28 offen lds
v_mfma_f32_16x16x32_bf16 v[96:99], v[124:127], v[120:123], 0
ds_read_b64_tr_b16 v[164:165], v16 offset:8192
v_mfma_f32_16x16x32_bf16 v[40:43], v[128:131], v[156:159], 0
ds_read_b64_tr_b16 v[166:167], v16 offset:10240
buffer_load_dwordx4 v9, s[4:7], s28 offen offset:1024 lds
v_mfma_f32_16x16x32_bf16 v[44:47], v[128:131], v[160:163], 0
ds_read_b64_tr_b16 v[168:169], v17 offset:8192
v_mfma_f32_16x16x32_bf16 v[100:103], v[128:131], v[120:123], 0
ds_read_b64_tr_b16 v[170:171], v17 offset:10240
buffer_load_dwordx4 v10, s[4:7], s28 offen offset:2048 lds
v_mfma_f32_16x16x32_bf16 v[48:51], v[132:135], v[156:159], 0
ds_read_b64_tr_b16 v[172:173], v18 offset:8192
v_mfma_f32_16x16x32_bf16 v[52:55], v[132:135], v[160:163], 0
ds_read_b64_tr_b16 v[174:175], v18 offset:10240
v_mfma_f32_16x16x32_bf16 v[104:107], v[120:123], v[156:159], 0
ds_read_b64_tr_b16 v[176:177], v19 offset:8192
buffer_load_dwordx4 v11, s[4:7], s28 offen offset:3072 lds
v_mfma_f32_16x16x32_bf16 v[56:59], v[136:139], v[156:159], 0
ds_read_b64_tr_b16 v[178:179], v19 offset:10240
v_mfma_f32_16x16x32_bf16 v[60:63], v[136:139], v[160:163], 0
ds_read_b64_tr_b16 v[180:181], v20 offset:8192
s_add_u32 m0, s35, 65536
s_nop 0
buffer_load_dwordx4 v12, s[8:11], s29 offen lds
v_mfma_f32_16x16x32_bf16 v[108:111], v[120:123], v[160:163], 0
ds_read_b64_tr_b16 v[182:183], v20 offset:10240
v_mfma_f32_16x16x32_bf16 v[64:67], v[140:143], v[156:159], 0
ds_read_b64_tr_b16 v[184:185], v21 offset:8192
buffer_load_dwordx4 v13, s[8:11], s29 offen offset:1024 lds
v_mfma_f32_16x16x32_bf16 v[68:71], v[140:143], v[160:163], 0
ds_read_b64_tr_b16 v[186:187], v21 offset:10240
v_mfma_f32_16x16x32_bf16 v[112:115], v[156:159], v[156:159], 0
ds_read_b64_tr_b16 v[188:189], v22 offset:8192
v_mfma_f32_16x16x32_bf16 v[72:75], v[144:147], v[156:159], 0
ds_read_b64_tr_b16 v[190:191], v22 offset:10240
buffer_load_dwordx4 v14, s[8:11], s29 offen offset:2048 lds
v_mfma_f32_16x16x32_bf16 v[76:79], v[144:147], v[160:163], 0
ds_read_b64_tr_b16 v[192:193], v23 offset:8192
v_mfma_f32_16x16x32_bf16 v[116:119], v[160:163], v[160:163], 0
ds_read_b64_tr_b16 v[194:195], v23 offset:10240
buffer_load_dwordx4 v15, s[8:11], s29 offen offset:3072 lds
s_add_u32 s28, s28, 128
s_add_u32 s29, s29, 196608
v_mfma_f32_16x16x32_bf16 v[80:83], v[148:151], v[156:159], 0
v_add_u32 v16, 32768, v16
v_add_u32 v17, 32768, v17
v_add_u32 v18, 32768, v18
v_mfma_f32_16x16x32_bf16 v[84:87], v[148:151], v[160:163], 0
v_add_u32 v19, 32768, v19
v_add_u32 v20, 32768, v20
v_add_u32 v21, 32768, v21
v_mfma_f32_16x16x32_bf16 v[88:91], v[152:155], v[156:159], 0
v_add_u32 v22, 32768, v22
v_add_u32 v23, 32768, v23
v_add_u32 v24, 32768, v24
v_mfma_f32_16x16x32_bf16 v[92:95], v[152:155], v[160:163], 0
v_add_u32 v25, 32768, v25
s_cmp_ge_u32 s3, 120
s_cbranch_scc1 G1_w0a
s_waitcnt vmcnt(12) lgkmcnt(0)
s_branch G1_w0b
G1_w0a:
s_waitcnt vmcnt(8) lgkmcnt(0)
G1_w0b:
s_barrier
v_mfma_f32_16x16x32_bf16 v[32:35], v[164:167], v[196:199], v[32:35]
ds_read_b128 v[156:159], v24 offset:0
v_mfma_f32_16x16x32_bf16 v[36:39], v[164:167], v[200:203], v[36:39]
ds_read_b128 v[160:163], v24 offset:2048
s_add_u32 m0, s34, 98304
s_nop 0
buffer_load_dwordx4 v8, s[4:7], s28 offen lds
v_mfma_f32_16x16x32_bf16 v[96:99], v[164:167], v[120:123], v[96:99]
ds_read_b64_tr_b16 v[124:125], v16 offset:0
v_mfma_f32_16x16x32_bf16 v[40:43], v[168:171], v[196:199], v[40:43]
ds_read_b64_tr_b16 v[126:127], v16 offset:2048
buffer_load_dwordx4 v9, s[4:7], s28 offen offset:1024 lds
v_mfma_f32_16x16x32_bf16 v[44:47], v[168:171], v[200:203], v[44:47]
ds_read_b64_tr_b16 v[128:129], v17 offset:0
v_mfma_f32_16x16x32_bf16 v[100:103], v[168:171], v[120:123], v[100:103]
ds_read_b64_tr_b16 v[130:131], v17 offset:2048
buffer_load_dwordx4 v10, s[4:7], s28 offen offset:2048 lds
v_mfma_f32_16x16x32_bf16 v[48:51], v[172:175], v[196:199], v[48:51]
ds_read_b64_tr_b16 v[132:133], v18 offset:0
v_mfma_f32_16x16x32_bf16 v[52:55], v[172:175], v[200:203], v[52:55]
ds_read_b64_tr_b16 v[134:135], v18 offset:2048
v_mfma_f32_16x16x32_bf16 v[104:107], v[120:123], v[196:199], v[104:107]
ds_read_b64_tr_b16 v[136:137], v19 offset:0
buffer_load_dwordx4 v11, s[4:7], s28 offen offset:3072 lds
v_mfma_f32_16x16x32_bf16 v[56:59], v[176:179], v[196:199], v[56:59]
ds_read_b64_tr_b16 v[138:139], v19 offset:2048
v_mfma_f32_16x16x32_bf16 v[60:63], v[176:179], v[200:203], v[60:63]
ds_read_b64_tr_b16 v[140:141], v20 offset:0
s_add_u32 m0, s35, 98304
s_nop 0
buffer_load_dwordx4 v12, s[8:11], s29 offen lds
v_mfma_f32_16x16x32_bf16 v[108:111], v[120:123], v[200:203], v[108:111]
ds_read_b64_tr_b16 v[142:143], v20 offset:2048
v_mfma_f32_16x16x32_bf16 v[64:67], v[180:183], v[196:199], v[64:67]
ds_read_b64_tr_b16 v[144:145], v21 offset:0
buffer_load_dwordx4 v13, s[8:11], s29 offen offset:1024 lds
v_mfma_f32_16x16x32_bf16 v[68:71], v[180:183], v[200:203], v[68:71]
ds_read_b64_tr_b16 v[146:147], v21 offset:2048
v_mfma_f32_16x16x32_bf16 v[112:115], v[196:199], v[196:199], v[112:115]
ds_read_b64_tr_b16 v[148:149], v22 offset:0
v_mfma_f32_16x16x32_bf16 v[72:75], v[184:187], v[196:199], v[72:75]
ds_read_b64_tr_b16 v[150:151], v22 offset:2048
buffer_load_dwordx4 v14, s[8:11], s29 offen offset:2048 lds
v_mfma_f32_16x16x32_bf16 v[76:79], v[184:187], v[200:203], v[76:79]
ds_read_b64_tr_b16 v[152:153], v23 offset:0
v_mfma_f32_16x16x32_bf16 v[116:119], v[200:203], v[200:203], v[116:119]
ds_read_b64_tr_b16 v[154:155], v23 offset:2048
buffer_load_dwordx4 v15, s[8:11], s29 offen offset:3072 lds
s_add_u32 s28, s28, 128
s_add_u32 s29, s29, 196608
v_mfma_f32_16x16x32_bf16 v[80:83], v[188:191], v[196:199], v[80:83]
v_mfma_f32_16x16x32_bf16 v[84:87], v[188:191], v[200:203], v[84:87]
v_mfma_f32_16x16x32_bf16 v[88:91], v[192:195], v[196:199], v[88:91]
v_mfma_f32_16x16x32_bf16 v[92:95], v[192:195], v[200:203], v[92:95]
s_waitcnt lgkmcnt(0)
v_mfma_f32_16x16x32_bf16 v[32:35], v[124:127], v[156:159], v[32:35]
ds_read_b128 v[196:199], v25 offset:0
v_mfma_f32_16x16x32_bf16 v[36:39], v[124:127], v[160:163], v[36:39]
ds_read_b128 v[200:203], v25 offset:2048
s_add_u32 m0, s34, 0
s_nop 0
buffer_load_dwordx4 v8, s[4:7], s28 offen lds
v_mfma_f32_16x16x32_bf16 v[96:99], v[124:127], v[120:123], v[96:99]
ds_read_b64_tr_b16 v[164:165], v16 offset:8192
v_mfma_f32_16x16x32_bf16 v[40:43], v[128:131], v[156:159], v[40:43]
ds_read_b64_tr_b16 v[166:167], v16 offset:10240
buffer_load_dwordx4 v9, s[4:7], s28 offen offset:1024 lds
v_mfma_f32_16x16x32_bf16 v[44:47], v[128:131], v[160:163], v[44:47]
ds_read_b64_tr_b16 v[168:169], v17 offset:8192
v_mfma_f32_16x16x32_bf16 v[100:103], v[128:131], v[120:123], v[100:103]
ds_read_b64_tr_b16 v[170:171], v17 offset:10240
buffer_load_dwordx4 v10, s[4:7], s28 offen offset:2048 lds
v_mfma_f32_16x16x32_bf16 v[48:51], v[132:135], v[156:159], v[48:51]
ds_read_b64_tr_b16 v[172:173], v18 offset:8192
v_mfma_f32_16x16x32_bf16 v[52:55], v[132:135], v[160:163], v[52:55]
ds_read_b64_tr_b16 v[174:175], v18 offset:10240
v_mfma_f32_16x16x32_bf16 v[104:107], v[120:123], v[156:159], v[104:107]
ds_read_b64_tr_b16 v[176:177], v19 offset:8192
buffer_load_dwordx4 v11, s[4:7], s28 offen offset:3072 lds
v_mfma_f32_16x16x32_bf16 v[56:59], v[136:139], v[156:159], v[56:59]
ds_read_b64_tr_b16 v[178:179], v19 offset:10240
v_mfma_f32_16x16x32_bf16 v[60:63], v[136:139], v[160:163], v[60:63]
ds_read_b64_tr_b16 v[180:181], v20 offset:8192
s_add_u32 m0, s35, 0
s_nop 0
buffer_load_dwordx4 v12, s[8:11], s29 offen lds
v_mfma_f32_16x16x32_bf16 v[108:111], v[120:123], v[160:163], v[108:111]
ds_read_b64_tr_b16 v[182:183], v20 offset:10240
v_mfma_f32_16x16x32_bf16 v[64:67], v[140:143], v[156:159], v[64:67]
ds_read_b64_tr_b16 v[184:185], v21 offset:8192
buffer_load_dwordx4 v13, s[8:11], s29 offen offset:1024 lds
v_mfma_f32_16x16x32_bf16 v[68:71], v[140:143], v[160:163], v[68:71]
ds_read_b64_tr_b16 v[186:187], v21 offset:10240
v_mfma_f32_16x16x32_bf16 v[112:115], v[156:159], v[156:159], v[112:115]
ds_read_b64_tr_b16 v[188:189], v22 offset:8192
v_mfma_f32_16x16x32_bf16 v[72:75], v[144:147], v[156:159], v[72:75]
ds_read_b64_tr_b16 v[190:191], v22 offset:10240
buffer_load_dwordx4 v14, s[8:11], s29 offen offset:2048 lds
v_mfma_f32_16x16x32_bf16 v[76:79], v[144:147], v[160:163], v[76:79]
ds_read_b64_tr_b16 v[192:193], v23 offset:8192
v_mfma_f32_16x16x32_bf16 v[116:119], v[160:163], v[160:163], v[116:119]
ds_read_b64_tr_b16 v[194:195], v23 offset:10240
buffer_load_dwordx4 v15, s[8:11], s29 offen offset:3072 lds
s_add_u32 s28, s28, 128
s_add_u32 s29, s29, 196608
v_mfma_f32_16x16x32_bf16 v[80:83], v[148:151], v[156:159], v[80:83]
v_add_u32 v16, 32768, v16
v_add_u32 v17, 32768, v17
v_add_u32 v18, 32768, v18
v_mfma_f32_16x16x32_bf16 v[84:87], v[148:151], v[160:163], v[84:87]
v_add_u32 v19, 32768, v19
v_add_u32 v20, 32768, v20
v_add_u32 v21, 32768, v21
v_mfma_f32_16x16x32_bf16 v[88:91], v[152:155], v[156:159], v[88:91]
v_add_u32 v22, 32768, v22
v_add_u32 v23, 32768, v23
v_add_u32 v24, 32768, v24
v_mfma_f32_16x16x32_bf16 v[92:95], v[152:155], v[160:163], v[92:95]
v_add_u32 v25, 32768, v25
s_waitcnt vmcnt(16) lgkmcnt(0)
s_barrier
v_mfma_f32_16x16x32_bf16 v[32:35], v[164:167], v[196:199], v[32:35]
ds_read_b128 v[156:159], v24 offset:0
v_mfma_f32_16x16x32_bf16 v[36:39], v[164:167], v[200:203], v[36:39]
ds_read_b128 v[160:163], v24 offset:2048
s_add_u32 m0, s34, 32768
s_nop 0
buffer_load_dwordx4 v8, s[4:7], s28 offen lds
v_mfma_f32_16x16x32_bf16 v[96:99], v[164:167], v[120:123], v[96:99]
ds_read_b64_tr_b16 v[124:125], v16 offset:0
v_mfma_f32_16x16x32_bf16 v[40:43], v[168:171], v[196:199], v[40:43]
ds_read_b64_tr_b16 v[126:127], v16 offset:2048
buffer_load_dwordx4 v9, s[4:7], s28 offen offset:1024 lds
v_mfma_f32_16x16x32_bf16 v[44:47], v[168:171], v[200:203], v[44:47]
ds_read_b64_tr_b16 v[128:129], v17 offset:0
v_mfma_f32_16x16x32_bf16 v[100:103], v[168:171], v[120:123], v[100:103]
ds_read_b64_tr_b16 v[130:131], v17 offset:2048
buffer_load_dwordx4 v10, s[4:7], s28 offen offset:2048 lds
v_mfma_f32_16x16x32_bf16 v[48:51], v[172:175], v[196:199], v[48:51]
ds_read_b64_tr_b16 v[132:133], v18 offset:0
v_mfma_f32_16x16x32_bf16 v[52:55], v[172:175], v[200:203], v[52:55]
ds_read_b64_tr_b16 v[134:135], v18 offset:2048
v_mfma_f32_16x16x32_bf16 v[104:107], v[120:123], v[196:199], v[104:107]
ds_read_b64_tr_b16 v[136:137], v19 offset:0
buffer_load_dwordx4 v11, s[4:7], s28 offen offset:3072 lds
v_mfma_f32_16x16x32_bf16 v[56:59], v[176:179], v[196:199], v[56:59]
ds_read_b64_tr_b16 v[138:139], v19 offset:2048
v_mfma_f32_16x16x32_bf16 v[60:63], v[176:179], v[200:203], v[60:63]
ds_read_b64_tr_b16 v[140:141], v20 offset:0
s_add_u32 m0, s35, 32768
s_nop 0
buffer_load_dwordx4 v12, s[8:11], s29 offen lds
v_mfma_f32_16x16x32_bf16 v[108:111], v[120:123], v[200:203], v[108:111]
ds_read_b64_tr_b16 v[142:143], v20 offset:2048
v_mfma_f32_16x16x32_bf16 v[64:67], v[180:183], v[196:199], v[64:67]
ds_read_b64_tr_b16 v[144:145], v21 offset:0
buffer_load_dwordx4 v13, s[8:11], s29 offen offset:1024 lds
v_mfma_f32_16x16x32_bf16 v[68:71], v[180:183], v[200:203], v[68:71]
ds_read_b64_tr_b16 v[146:147], v21 offset:2048
v_mfma_f32_16x16x32_bf16 v[112:115], v[196:199], v[196:199], v[112:115]
ds_read_b64_tr_b16 v[148:149], v22 offset:0
v_mfma_f32_16x16x32_bf16 v[72:75], v[184:187], v[196:199], v[72:75]
ds_read_b64_tr_b16 v[150:151], v22 offset:2048
buffer_load_dwordx4 v14, s[8:11], s29 offen offset:2048 lds
v_mfma_f32_16x16x32_bf16 v[76:79], v[184:187], v[200:203], v[76:79]
ds_read_b64_tr_b16 v[152:153], v23 offset:0
v_mfma_f32_16x16x32_bf16 v[116:119], v[200:203], v[200:203], v[116:119]
ds_read_b64_tr_b16 v[154:155], v23 offset:2048
buffer_load_dwordx4 v15, s[8:11], s29 offen offset:3072 lds
s_add_u32 s28, s28, 128
s_add_u32 s29, s29, 196608
v_mfma_f32_16x16x32_bf16 v[80:83], v[188:191], v[196:199], v[80:83]
v_mfma_f32_16x16x32_bf16 v[84:87], v[188:191], v[200:203], v[84:87]
v_mfma_f32_16x16x32_bf16 v[88:91], v[192:195], v[196:199], v[88:91]
v_mfma_f32_16x16x32_bf16 v[92:95], v[192:195], v[200:203], v[92:95]
s_waitcnt lgkmcnt(0)
s_mov_b32 s27, 2
s_mov_b32 s64, 32768
.p2align 5
G1_loop:
v_mfma_f32_16x16x32_bf16 v[32:35], v[124:127], v[156:159], v[32:35]
ds_read_b128 v[196:199], v25 offset:0
s_and_b32 s33, s27, 3
v_mfma_f32_16x16x32_bf16 v[36:39], v[124:127], v[160:163], v[36:39]
ds_read_b128 v[200:203], v25 offset:2048
s_mul_i32 s30, s33, 32768
v_mfma_f32_16x16x32_bf16 v[96:99], v[124:127], v[120:123], v[96:99]
ds_read_b64_tr_b16 v[164:165], v16 offset:8192
s_cmp_eq_u32 s33, 3
v_mfma_f32_16x16x32_bf16 v[40:43], v[128:131], v[156:159], v[40:43]
ds_read_b64_tr_b16 v[166:167], v16 offset:10240
s_cselect_b32 s32, -98304, s64
v_mfma_f32_16x16x32_bf16 v[44:47], v[128:131], v[160:163], v[44:47]
ds_read_b64_tr_b16 v[168:169], v17 offset:8192
v_mfma_f32_16x16x32_bf16 v[100:103], v[128:131], v[120:123], v[100:103]
ds_read_b64_tr_b16 v[170:171], v17 offset:10240
v_mfma_f32_16x16x32_bf16 v[48:51], v[132:135], v[156:159], v[48:51]
ds_read_b64_tr_b16 v[172:173], v18 offset:8192
v_mfma_f32_16x16x32_bf16 v[52:55], v[132:135], v[160:163], v[52:55]
ds_read_b64_tr_b16 v[174:175], v18 offset:10240
v_mfma_f32_16x16x32_bf16 v[104:107], v[120:123], v[156:159], v[104:107]
ds_read_b64_tr_b16 v[176:177], v19 offset:8192
v_mfma_f32_16x16x32_bf16 v[56:59], v[136:139], v[156:159], v[56:59]
ds_read_b64_tr_b16 v[178:179], v19 offset:10240
v_mfma_f32_16x16x32_bf16 v[60:63], v[136:139], v[160:163], v[60:63]
ds_read_b64_tr_b16 v[180:181], v20 offset:8192
v_mfma_f32_16x16x32_bf16 v[108:111], v[120:123], v[160:163], v[108:111]
ds_read_b64_tr_b16 v[182:183], v20 offset:10240
v_mfma_f32_16x16x32_bf16 v[64:67], v[140:143], v[156:159], v[64:67]
ds_read_b64_tr_b16 v[184:185], v21 offset:8192
v_mfma_f32_16x16x32_bf16 v[68:71], v[140:143], v[160:163], v[68:71]
ds_read_b64_tr_b16 v[186:187], v21 offset:10240
v_mfma_f32_16x16x32_bf16 v[112:115], v[156:159], v[156:159], v[112:115]
ds_read_b64_tr_b16 v[188:189], v22 offset:8192
v_mfma_f32_16x16x32_bf16 v[72:75], v[144:147], v[156:159], v[72:75]
ds_read_b64_tr_b16 v[190:191], v22 offset:10240
v_mfma_f32_16x16x32_bf16 v[76:79], v[144:147], v[160:163], v[76:79]
ds_read_b64_tr_b16 v[192:193], v23 offset:8192
v_mfma_f32_16x16x32_bf16 v[116:119], v[160:163], v[160:163], v[116:119]
ds_read_b64_tr_b16 v[194:195], v23 offset:10240
v_mfma_f32_16x16x32_bf16 v[80:83], v[148:151], v[156:159], v[80:83]
v_add_u32 v16, s32, v16
v_add_u32 v17, s32, v17
v_add_u32 v18, s32, v18
v_mfma_f32_16x16x32_bf16 v[84:87], v[148:151], v[160:163], v[84:87]
v_add_u32 v19, s32, v19
v_add_u32 v20, s32, v20
v_add_u32 v21, s32, v21
v_mfma_f32_16x16x32_bf16 v[88:91], v[152:155], v[156:159], v[88:91]
v_add_u32 v22, s32, v22
v_add_u32 v23, s32, v23
v_add_u32 v24, s32, v24
v_mfma_f32_16x16x32_bf16 v[92:95], v[152:155], v[160:163], v[92:95]
v_add_u32 v25, s32, v25
s_waitcnt vmcnt(16) lgkmcnt(0)
s_barrier
s_cmp_eq_u32 s27, s92
s_cbranch_scc1 G1_sig
G1_sigd:
v_mfma_f32_16x16x32_bf16 v[32:35], v[164:167], v[196:199], v[32:35]
ds_read_b128 v[156:159], v24 offset:0
v_mfma_f32_16x16x32_bf16 v[36:39], v[164:167], v[200:203], v[36:39]
ds_read_b128 v[160:163], v24 offset:2048
s_add_u32 m0, s30, s34
s_nop 0
buffer_load_dwordx4 v8, s[4:7], s28 offen lds
v_mfma_f32_16x16x32_bf16 v[96:99], v[164:167], v[120:123], v[96:99]
ds_read_b64_tr_b16 v[124:125], v16 offset:0
v_mfma_f32_16x16x32_bf16 v[40:43], v[168:171], v[196:199], v[40:43]
ds_read_b64_tr_b16 v[126:127], v16 offset:2048
buffer_load_dwordx4 v9, s[4:7], s28 offen offset:1024 lds
v_mfma_f32_16x16x32_bf16 v[44:47], v[168:171], v[200:203], v[44:47]
ds_read_b64_tr_b16 v[128:129], v17 offset:0
v_mfma_f32_16x16x32_bf16 v[100:103], v[168:171], v[120:123], v[100:103]
ds_read_b64_tr_b16 v[130:131], v17 offset:2048
buffer_load_dwordx4 v10, s[4:7], s28 offen offset:2048 lds
v_mfma_f32_16x16x32_bf16 v[48:51], v[172:175], v[196:199], v[48:51]
ds_read_b64_tr_b16 v[132:133], v18 offset:0
v_mfma_f32_16x16x32_bf16 v[52:55], v[172:175], v[200:203], v[52:55]
ds_read_b64_tr_b16 v[134:135], v18 offset:2048
v_mfma_f32_16x16x32_bf16 v[104:107], v[120:123], v[196:199], v[104:107]
ds_read_b64_tr_b16 v[136:137], v19 offset:0
buffer_load_dwordx4 v11, s[4:7], s28 offen offset:3072 lds
v_mfma_f32_16x16x32_bf16 v[56:59], v[176:179], v[196:199], v[56:59]
ds_read_b64_tr_b16 v[138:139], v19 offset:2048
v_mfma_f32_16x16x32_bf16 v[60:63], v[176:179], v[200:203], v[60:63]
ds_read_b64_tr_b16 v[140:141], v20 offset:0
s_add_u32 m0, s30, s35
s_nop 0
buffer_load_dwordx4 v12, s[8:11], s29 offen lds
v_mfma_f32_16x16x32_bf16 v[108:111], v[120:123], v[200:203], v[108:111]
ds_read_b64_tr_b16 v[142:143], v20 offset:2048
v_mfma_f32_16x16x32_bf16 v[64:67], v[180:183], v[196:199], v[64:67]
ds_read_b64_tr_b16 v[144:145], v21 offset:0
buffer_load_dwordx4 v13, s[8:11], s29 offen offset:1024 lds
v_mfma_f32_16x16x32_bf16 v[68:71], v[180:183], v[200:203], v[68:71]
ds_read_b64_tr_b16 v[146:147], v21 offset:2048
v_mfma_f32_16x16x32_bf16 v[112:115], v[196:199], v[196:199], v[112:115]
ds_read_b64_tr_b16 v[148:149], v22 offset:0
v_mfma_f32_16x16x32_bf16 v[72:75], v[184:187], v[196:199], v[72:75]
ds_read_b64_tr_b16 v[150:151], v22 offset:2048
buffer_load_dwordx4 v14, s[8:11], s29 offen offset:2048 lds
v_mfma_f32_16x16x32_bf16 v[76:79], v[184:187], v[200:203], v[76:79]
ds_read_b64_tr_b16 v[152:153], v23 offset:0
v_mfma_f32_16x16x32_bf16 v[116:119], v[200:203], v[200:203], v[116:119]
ds_read_b64_tr_b16 v[154:155], v23 offset:2048
buffer_load_dwordx4 v15, s[8:11], s29 offen offset:3072 lds
v_mfma_f32_16x16x32_bf16 v[80:83], v[188:191], v[196:199], v[80:83]
v_mfma_f32_16x16x32_bf16 v[84:87], v[188:191], v[200:203], v[84:87]
v_mfma_f32_16x16x32_bf16 v[88:91], v[192:195], v[196:199], v[88:91]
s_add_u32 s28, s28, 128
s_add_u32 s29, s29, 196608
s_add_u32 s27, s27, 1
v_mfma_f32_16x16x32_bf16 v[92:95], v[192:195], v[200:203], v[92:95]
s_cmp_lt_u32 s27, 6
s_waitcnt lgkmcnt(0)
s_cbranch_scc1 G1_loop
v_mfma_f32_16x16x32_bf16 v[32:35], v[124:127], v[156:159], v[32:35]
ds_read_b128 v[196:199], v25 offset:0
v_mfma_f32_16x16x32_bf16 v[36:39], v[124:127], v[160:163], v[36:39]
ds_read_b128 v[200:203], v25 offset:2048
v_mfma_f32_16x16x32_bf16 v[96:99], v[124:127], v[120:123], v[96:99]
ds_read_b64_tr_b16 v[164:165], v16 offset:8192
v_mfma_f32_16x16x32_bf16 v[40:43], v[128:131], v[156:159], v[40:43]
ds_read_b64_tr_b16 v[166:167], v16 offset:10240
v_mfma_f32_16x16x32_bf16 v[44:47], v[128:131], v[160:163], v[44:47]
ds_read_b64_tr_b16 v[168:169], v17 offset:8192
v_mfma_f32_16x16x32_bf16 v[100:103], v[128:131], v[120:123], v[100:103]
ds_read_b64_tr_b16 v[170:171], v17 offset:10240
v_mfma_f32_16x16x32_bf16 v[48:51], v[132:135], v[156:159], v[48:51]
ds_read_b64_tr_b16 v[172:173], v18 offset:8192
v_mfma_f32_16x16x32_bf16 v[52:55], v[132:135], v[160:163], v[52:55]
ds_read_b64_tr_b16 v[174:175], v18 offset:10240
v_mfma_f32_16x16x32_bf16 v[104:107], v[120:123], v[156:159], v[104:107]
ds_read_b64_tr_b16 v[176:177], v19 offset:8192
v_mfma_f32_16x16x32_bf16 v[56:59], v[136:139], v[156:159], v[56:59]
ds_read_b64_tr_b16 v[178:179], v19 offset:10240
v_mfma_f32_16x16x32_bf16 v[60:63], v[136:139], v[160:163], v[60:63]
ds_read_b64_tr_b16 v[180:181], v20 offset:8192
v_mfma_f32_16x16x32_bf16 v[108:111], v[120:123], v[160:163], v[108:111]
ds_read_b64_tr_b16 v[182:183], v20 offset:10240
v_mfma_f32_16x16x32_bf16 v[64:67], v[140:143], v[156:159], v[64:67]
ds_read_b64_tr_b16 v[184:185], v21 offset:8192
v_mfma_f32_16x16x32_bf16 v[68:71], v[140:143], v[160:163], v[68:71]
ds_read_b64_tr_b16 v[186:187], v21 offset:10240
v_mfma_f32_16x16x32_bf16 v[112:115], v[156:159], v[156:159], v[112:115]
ds_read_b64_tr_b16 v[188:189], v22 offset:8192
v_mfma_f32_16x16x32_bf16 v[72:75], v[144:147], v[156:159], v[72:75]
ds_read_b64_tr_b16 v[190:191], v22 offset:10240
v_mfma_f32_16x16x32_bf16 v[76:79], v[144:147], v[160:163], v[76:79]
ds_read_b64_tr_b16 v[192:193], v23 offset:8192
v_mfma_f32_16x16x32_bf16 v[116:119], v[160:163], v[160:163], v[116:119]
ds_read_b64_tr_b16 v[194:195], v23 offset:10240
v_mfma_f32_16x16x32_bf16 v[80:83], v[148:151], v[156:159], v[80:83]
v_add_u32 v16, 32768, v16
v_add_u32 v17, 32768, v17
v_add_u32 v18, 32768, v18
v_mfma_f32_16x16x32_bf16 v[84:87], v[148:151], v[160:163], v[84:87]
v_add_u32 v19, 32768, v19
v_add_u32 v20, 32768, v20
v_add_u32 v21, 32768, v21
v_mfma_f32_16x16x32_bf16 v[88:91], v[152:155], v[156:159], v[88:91]
v_add_u32 v22, 32768, v22
v_add_u32 v23, 32768, v23
v_add_u32 v24, 32768, v24
v_mfma_f32_16x16x32_bf16 v[92:95], v[152:155], v[160:163], v[92:95]
v_add_u32 v25, 32768, v25
s_waitcnt vmcnt(16) lgkmcnt(0)
s_barrier
v_mfma_f32_16x16x32_bf16 v[32:35], v[164:167], v[196:199], v[32:35]
ds_read_b128 v[156:159], v24 offset:0
v_mfma_f32_16x16x32_bf16 v[36:39], v[164:167], v[200:203], v[36:39]
ds_read_b128 v[160:163], v24 offset:2048
s_mov_b64 exec, 0x3fffffff
global_load_dword v30, v29, s[86:87] sc1
s_mov_b64 exec, -1
v_mfma_f32_16x16x32_bf16 v[96:99], v[164:167], v[120:123], v[96:99]
ds_read_b64_tr_b16 v[124:125], v16 offset:0
v_mfma_f32_16x16x32_bf16 v[40:43], v[168:171], v[196:199], v[40:43]
ds_read_b64_tr_b16 v[126:127], v16 offset:2048
v_mfma_f32_16x16x32_bf16 v[44:47], v[168:171], v[200:203], v[44:47]
ds_read_b64_tr_b16 v[128:129], v17 offset:0
v_mfma_f32_16x16x32_bf16 v[100:103], v[168:171], v[120:123], v[100:103]
ds_read_b64_tr_b16 v[130:131], v17 offset:2048
v_mfma_f32_16x16x32_bf16 v[48:51], v[172:175], v[196:199], v[48:51]
ds_read_b64_tr_b16 v[132:133], v18 offset:0
v_mfma_f32_16x16x32_bf16 v[52:55], v[172:175], v[200:203], v[52:55]
ds_read_b64_tr_b16 v[134:135], v18 offset:2048
v_mfma_f32_16x16x32_bf16 v[104:107], v[120:123], v[196:199], v[104:107]
ds_read_b64_tr_b16 v[136:137], v19 offset:0
v_mfma_f32_16x16x32_bf16 v[56:59], v[176:179], v[196:199], v[56:59]
ds_read_b64_tr_b16 v[138:139], v19 offset:2048
v_mfma_f32_16x16x32_bf16 v[60:63], v[176:179], v[200:203], v[60:63]
ds_read_b64_tr_b16 v[140:141], v20 offset:0
v_mfma_f32_16x16x32_bf16 v[108:111], v[120:123], v[200:203], v[108:111]
ds_read_b64_tr_b16 v[142:143], v20 offset:2048
v_mfma_f32_16x16x32_bf16 v[64:67], v[180:183], v[196:199], v[64:67]
ds_read_b64_tr_b16 v[144:145], v21 offset:0
v_mfma_f32_16x16x32_bf16 v[68:71], v[180:183], v[200:203], v[68:71]
ds_read_b64_tr_b16 v[146:147], v21 offset:2048
v_mfma_f32_16x16x32_bf16 v[112:115], v[196:199], v[196:199], v[112:115]
ds_read_b64_tr_b16 v[148:149], v22 offset:0
v_mfma_f32_16x16x32_bf16 v[72:75], v[184:187], v[196:199], v[72:75]
ds_read_b64_tr_b16 v[150:151], v22 offset:2048
v_mfma_f32_16x16x32_bf16 v[76:79], v[184:187], v[200:203], v[76:79]
ds_read_b64_tr_b16 v[152:153], v23 offset:0
v_mfma_f32_16x16x32_bf16 v[116:119], v[200:203], v[200:203], v[116:119]
ds_read_b64_tr_b16 v[154:155], v23 offset:2048
v_mfma_f32_16x16x32_bf16 v[80:83], v[188:191], v[196:199], v[80:83]
v_mfma_f32_16x16x32_bf16 v[84:87], v[188:191], v[200:203], v[84:87]
v_mfma_f32_16x16x32_bf16 v[88:91], v[192:195], v[196:199], v[88:91]
v_mfma_f32_16x16x32_bf16 v[92:95], v[192:195], v[200:203], v[92:95]
s_waitcnt lgkmcnt(0)
v_mfma_f32_16x16x32_bf16 v[32:35], v[124:127], v[156:159], v[32:35]
ds_read_b128 v[196:199], v25 offset:0
v_mfma_f32_16x16x32_bf16 v[36:39], v[124:127], v[160:163], v[36:39]
ds_read_b128 v[200:203], v25 offset:2048
v_mfma_f32_16x16x32_bf16 v[96:99], v[124:127], v[120:123], v[96:99]
ds_read_b64_tr_b16 v[164:165], v16 offset:8192
v_mfma_f32_16x16x32_bf16 v[40:43], v[128:131], v[156:159], v[40:43]
ds_read_b64_tr_b16 v[166:167], v16 offset:10240
v_mfma_f32_16x16x32_bf16 v[44:47], v[128:131], v[160:163], v[44:47]
ds_read_b64_tr_b16 v[168:169], v17 offset:8192
v_mfma_f32_16x16x32_bf16 v[100:103], v[128:131], v[120:123], v[100:103]
ds_read_b64_tr_b16 v[170:171], v17 offset:10240
v_mfma_f32_16x16x32_bf16 v[48:51], v[132:135], v[156:159], v[48:51]
ds_read_b64_tr_b16 v[172:173], v18 offset:8192
v_mfma_f32_16x16x32_bf16 v[52:55], v[132:135], v[160:163], v[52:55]
ds_read_b64_tr_b16 v[174:175], v18 offset:10240
v_mfma_f32_16x16x32_bf16 v[104:107], v[120:123], v[156:159], v[104:107]
ds_read_b64_tr_b16 v[176:177], v19 offset:8192
v_mfma_f32_16x16x32_bf16 v[56:59], v[136:139], v[156:159], v[56:59]
ds_read_b64_tr_b16 v[178:179], v19 offset:10240
v_mfma_f32_16x16x32_bf16 v[60:63], v[136:139], v[160:163], v[60:63]
ds_read_b64_tr_b16 v[180:181], v20 offset:8192
v_mfma_f32_16x16x32_bf16 v[108:111], v[120:123], v[160:163], v[108:111]
ds_read_b64_tr_b16 v[182:183], v20 offset:10240
v_mfma_f32_16x16x32_bf16 v[64:67], v[140:143], v[156:159], v[64:67]
ds_read_b64_tr_b16 v[184:185], v21 offset:8192
v_mfma_f32_16x16x32_bf16 v[68:71], v[140:143], v[160:163], v[68:71]
ds_read_b64_tr_b16 v[186:187], v21 offset:10240
v_mfma_f32_16x16x32_bf16 v[112:115], v[156:159], v[156:159], v[112:115]
ds_read_b64_tr_b16 v[188:189], v22 offset:8192
v_mfma_f32_16x16x32_bf16 v[72:75], v[144:147], v[156:159], v[72:75]
ds_read_b64_tr_b16 v[190:191], v22 offset:10240
v_mfma_f32_16x16x32_bf16 v[76:79], v[144:147], v[160:163], v[76:79]
ds_read_b64_tr_b16 v[192:193], v23 offset:8192
v_mfma_f32_16x16x32_bf16 v[116:119], v[160:163], v[160:163], v[116:119]
ds_read_b64_tr_b16 v[194:195], v23 offset:10240
v_mfma_f32_16x16x32_bf16 v[80:83], v[148:151], v[156:159], v[80:83]
v_add_u32 v16, -98304, v16
v_add_u32 v17, -98304, v17
v_add_u32 v18, -98304, v18
v_mfma_f32_16x16x32_bf16 v[84:87], v[148:151], v[160:163], v[84:87]
v_add_u32 v19, -98304, v19
v_add_u32 v20, -98304, v20
v_add_u32 v21, -98304, v21
v_mfma_f32_16x16x32_bf16 v[88:91], v[152:155], v[156:159], v[88:91]
v_add_u32 v22, -98304, v22
v_add_u32 v23, -98304, v23
v_add_u32 v24, -98304, v24
v_mfma_f32_16x16x32_bf16 v[92:95], v[152:155], v[160:163], v[92:95]
v_add_u32 v25, -98304, v25
s_waitcnt vmcnt(0) lgkmcnt(0)
s_barrier
s_mov_b64 exec, 0x3fffffff
v_cmp_ne_u32 vcc, s65, v30
s_mov_b64 exec, -1
s_nop 2
s_cbranch_vccnz G1_wsp
G1_wok:
v_mfma_f32_16x16x32_bf16 v[32:35], v[164:167], v[196:199], v[32:35]
ds_read_b128 v[156:159], v24 offset:0
v_mfma_f32_16x16x32_bf16 v[36:39], v[164:167], v[200:203], v[36:39]
ds_read_b128 v[160:163], v24 offset:2048
buffer_load_dwordx4 a[0:3], v254, s[16:19], s94 offen offset:0 sc1
v_mfma_f32_16x16x32_bf16 v[96:99], v[164:167], v[120:123], v[96:99]
ds_read_b64_tr_b16 v[124:125], v16 offset:0
v_mfma_f32_16x16x32_bf16 v[40:43], v[168:171], v[196:199], v[40:43]
ds_read_b64_tr_b16 v[126:127], v16 offset:2048
buffer_load_dwordx4 a[4:7], v254, s[16:19], s94 offen offset:1024 sc1
v_mfma_f32_16x16x32_bf16 v[44:47], v[168:171], v[200:203], v[44:47]
ds_read_b64_tr_b16 v[128:129], v17 offset:0
v_mfma_f32_16x16x32_bf16 v[100:103], v[168:171], v[120:123], v[100:103]
ds_read_b64_tr_b16 v[130:131], v17 offset:2048
v_mfma_f32_16x16x32_bf16 v[48:51], v[172:175], v[196:199], v[48:51]
ds_read_b64_tr_b16 v[132:133], v18 offset:0
buffer_load_dwordx4 a[8:11], v254, s[16:19], s94 offen offset:2048 sc1
v_mfma_f32_16x16x32_bf16 v[52:55], v[172:175], v[200:203], v[52:55]
ds_read_b64_tr_b16 v[134:135], v18 offset:2048
v_mfma_f32_16x16x32_bf16 v[104:107], v[120:123], v[196:199], v[104:107]
ds_read_b64_tr_b16 v[136:137], v19 offset:0
v_mfma_f32_16x16x32_bf16 v[56:59], v[176:179], v[196:199], v[56:59]
ds_read_b64_tr_b16 v[138:139], v19 offset:2048
buffer_load_dwordx4 a[12:15], v254, s[16:19], s94 offen offset:3072 sc1
v_add_u32 v254, 4096, v254
v_mfma_f32_16x16x32_bf16 v[60:63], v[176:179], v[200:203], v[60:63]
ds_read_b64_tr_b16 v[140:141], v20 offset:0
v_mfma_f32_16x16x32_bf16 v[108:111], v[120:123], v[200:203], v[108:111]
ds_read_b64_tr_b16 v[142:143], v20 offset:2048
buffer_load_dwordx4 a[16:19], v254, s[16:19], s94 offen offset:0 sc1
v_mfma_f32_16x16x32_bf16 v[64:67], v[180:183], v[196:199], v[64:67]
ds_read_b64_tr_b16 v[144:145], v21 offset:0
v_mfma_f32_16x16x32_bf16 v[68:71], v[180:183], v[200:203], v[68:71]
ds_read_b64_tr_b16 v[146:147], v21 offset:2048
v_mfma_f32_16x16x32_bf16 v[112:115], v[196:199], v[196:199], v[112:115]
ds_read_b64_tr_b16 v[148:149], v22 offset:0
buffer_load_dwordx4 a[20:23], v254, s[16:19], s94 offen offset:1024 sc1
v_mfma_f32_16x16x32_bf16 v[72:75], v[184:187], v[196:199], v[72:75]
ds_read_b64_tr_b16 v[150:151], v22 offset:2048
v_mfma_f32_16x16x32_bf16 v[76:79], v[184:187], v[200:203], v[76:79]
ds_read_b64_tr_b16 v[152:153], v23 offset:0
v_mfma_f32_16x16x32_bf16 v[116:119], v[200:203], v[200:203], v[116:119]
ds_read_b64_tr_b16 v[154:155], v23 offset:2048
buffer_load_dwordx4 a[24:27], v254, s[16:19], s94 offen offset:2048 sc1
v_mfma_f32_16x16x32_bf16 v[80:83], v[188:191], v[196:199], v[80:83]
v_mfma_f32_16x16x32_bf16 v[84:87], v[188:191], v[200:203], v[84:87]
v_mfma_f32_16x16x32_bf16 v[88:91], v[192:195], v[196:199], v[88:91]
v_mfma_f32_16x16x32_bf16 v[92:95], v[192:195], v[200:203], v[92:95]
s_waitcnt lgkmcnt(0)
v_mfma_f32_16x16x32_bf16 v[32:35], v[124:127], v[156:159], v[32:35]
ds_read_b128 v[196:199], v25 offset:0
v_mfma_f32_16x16x32_bf16 v[36:39], v[124:127], v[160:163], v[36:39]
ds_read_b128 v[200:203], v25 offset:2048
buffer_load_dwordx4 a[28:31], v254, s[16:19], s94 offen offset:3072 sc1
v_add_u32 v254, 4096, v254
v_mfma_f32_16x16x32_bf16 v[96:99], v[124:127], v[120:123], v[96:99]
ds_read_b64_tr_b16 v[164:165], v16 offset:8192
v_mfma_f32_16x16x32_bf16 v[40:43], v[128:131], v[156:159], v[40:43]
ds_read_b64_tr_b16 v[166:167], v16 offset:10240
buffer_load_dwordx4 a[32:35], v254, s[16:19], s94 offen offset:0 sc1
v_mfma_f32_16x16x32_bf16 v[44:47], v[128:131], v[160:163], v[44:47]
ds_read_b64_tr_b16 v[168:169], v17 offset:8192
v_mfma_f32_16x16x32_bf16 v[100:103], v[128:131], v[120:123], v[100:103]
ds_read_b64_tr_b16 v[170:171], v17 offset:10240
v_mfma_f32_16x16x32_bf16 v[48:51], v[132:135], v[156:159], v[48:51]
ds_read_b64_tr_b16 v[172:173], v18 offset:8192
buffer_load_dwordx4 a[36:39], v254, s[16:19], s94 offen offset:1024 sc1
v_mfma_f32_16x16x32_bf16 v[52:55], v[132:135], v[160:163], v[52:55]
ds_read_b64_tr_b16 v[174:175], v18 offset:10240
v_mfma_f32_16x16x32_bf16 v[104:107], v[120:123], v[156:159], v[104:107]
ds_read_b64_tr_b16 v[176:177], v19 offset:8192
v_mfma_f32_16x16x32_bf16 v[56:59], v[136:139], v[156:159], v[56:59]
ds_read_b64_tr_b16 v[178:179], v19 offset:10240
buffer_load_dwordx4 a[40:43], v254, s[16:19], s94 offen offset:2048 sc1
v_mfma_f32_16x16x32_bf16 v[60:63], v[136:139], v[160:163], v[60:63]
ds_read_b64_tr_b16 v[180:181], v20 offset:8192
v_mfma_f32_16x16x32_bf16 v[108:111], v[120:123], v[160:163], v[108:111]
ds_read_b64_tr_b16 v[182:183], v20 offset:10240
buffer_load_dwordx4 a[44:47], v254, s[16:19], s94 offen offset:3072 sc1
v_add_u32 v254, 4096, v254
v_mfma_f32_16x16x32_bf16 v[64:67], v[140:143], v[156:159], v[64:67]
ds_read_b64_tr_b16 v[184:185], v21 offset:8192
v_mfma_f32_16x16x32_bf16 v[68:71], v[140:143], v[160:163], v[68:71]
ds_read_b64_tr_b16 v[186:187], v21 offset:10240
v_mfma_f32_16x16x32_bf16 v[112:115], v[156:159], v[156:159], v[112:115]
ds_read_b64_tr_b16 v[188:189], v22 offset:8192
buffer_load_dwordx4 a[48:51], v254, s[16:19], s94 offen offset:0 sc1
v_mfma_f32_16x16x32_bf16 v[72:75], v[144:147], v[156:159], v[72:75]
ds_read_b64_tr_b16 v[190:191], v22 offset:10240
v_mfma_f32_16x16x32_bf16 v[76:79], v[144:147], v[160:163], v[76:79]
ds_read_b64_tr_b16 v[192:193], v23 offset:8192
v_mfma_f32_16x16x32_bf16 v[116:119], v[160:163], v[160:163], v[116:119]
ds_read_b64_tr_b16 v[194:195], v23 offset:10240
buffer_load_dwordx4 a[52:55], v254, s[16:19], s94 offen offset:1024 sc1
v_mfma_f32_16x16x32_bf16 v[80:83], v[148:151], v[156:159], v[80:83]
v_add_u32 v16, 32768, v16
v_add_u32 v17, 32768, v17
v_add_u32 v18, 32768, v18
v_mfma_f32_16x16x32_bf16 v[84:87], v[148:151], v[160:163], v[84:87]
v_add_u32 v19, 32768, v19
v_add_u32 v20, 32768, v20
v_add_u32 v21, 32768, v21
v_mfma_f32_16x16x32_bf16 v[88:91], v[152:155], v[156:159], v[88:91]
v_add_u32 v22, 32768, v22
v_add_u32 v23, 32768, v23
v_add_u32 v24, 32768, v24
v_mfma_f32_16x16x32_bf16 v[92:95], v[152:155], v[160:163], v[92:95]
v_add_u32 v25, 32768, v25
s_waitcnt lgkmcnt(0)
s_barrier
v_mfma_f32_16x16x32_bf16 v[32:35], v[164:167], v[196:199], v[32:35]
ds_read_b128 v[156:159], v24 offset:0
v_mfma_f32_16x16x32_bf16 v[36:39], v[164:167], v[200:203], v[36:39]
ds_read_b128 v[160:163], v24 offset:2048
buffer_load_dwordx4 a[56:59], v254, s[16:19], s94 offen offset:2048 sc1
v_mfma_f32_16x16x32_bf16 v[96:99], v[164:167], v[120:123], v[96:99]
ds_read_b64_tr_b16 v[124:125], v16 offset:0
v_mfma_f32_16x16x32_bf16 v[40:43], v[168:171], v[196:199], v[40:43]
ds_read_b64_tr_b16 v[126:127], v16 offset:2048
buffer_load_dwordx4 a[60:63], v254, s[16:19], s94 offen offset:3072 sc1
v_add_u32 v254, 4096, v254
v_mfma_f32_16x16x32_bf16 v[44:47], v[168:171], v[200:203], v[44:47]
ds_read_b64_tr_b16 v[128:129], v17 offset:0
v_mfma_f32_16x16x32_bf16 v[100:103], v[168:171], v[120:123], v[100:103]
ds_read_b64_tr_b16 v[130:131], v17 offset:2048
v_mfma_f32_16x16x32_bf16 v[48:51], v[172:175], v[196:199], v[48:51]
ds_read_b64_tr_b16 v[132:133], v18 offset:0
buffer_load_dwordx4 a[64:67], v254, s[16:19], s94 offen offset:0 sc1
v_mfma_f32_16x16x32_bf16 v[52:55], v[172:175], v[200:203], v[52:55]
ds_read_b64_tr_b16 v[134:135], v18 offset:2048
v_mfma_f32_16x16x32_bf16 v[104:107], v[120:123], v[196:199], v[104:107]
ds_read_b64_tr_b16 v[136:137], v19 offset:0
v_mfma_f32_16x16x32_bf16 v[56:59], v[176:179], v[196:199], v[56:59]
ds_read_b64_tr_b16 v[138:139], v19 offset:2048
buffer_load_dwordx4 a[68:71], v254, s[16:19], s94 offen offset:1024 sc1
v_mfma_f32_16x16x32_bf16 v[60:63], v[176:179], v[200:203], v[60:63]
ds_read_b64_tr_b16 v[140:141], v20 offset:0
v_mfma_f32_16x16x32_bf16 v[108:111], v[120:123], v[200:203], v[108:111]
ds_read_b64_tr_b16 v[142:143], v20 offset:2048
buffer_load_dwordx4 a[72:75], v254, s[16:19], s94 offen offset:2048 sc1
v_mfma_f32_16x16x32_bf16 v[64:67], v[180:183], v[196:199], v[64:67]
ds_read_b64_tr_b16 v[144:145], v21 offset:0
v_mfma_f32_16x16x32_bf16 v[68:71], v[180:183], v[200:203], v[68:71]
ds_read_b64_tr_b16 v[146:147], v21 offset:2048
v_mfma_f32_16x16x32_bf16 v[112:115], v[196:199], v[196:199], v[112:115]
ds_read_b64_tr_b16 v[148:149], v22 offset:0
buffer_load_dwordx4 a[76:79], v254, s[16:19], s94 offen offset:3072 sc1
v_add_u32 v254, 4096, v254
v_mfma_f32_16x16x32_bf16 v[72:75], v[184:187], v[196:199], v[72:75]
ds_read_b64_tr_b16 v[150:151], v22 offset:2048
v_mfma_f32_16x16x32_bf16 v[76:79], v[184:187], v[200:203], v[76:79]
ds_read_b64_tr_b16 v[152:153], v23 offset:0
v_mfma_f32_16x16x32_bf16 v[116:119], v[200:203], v[200:203], v[116:119]
ds_read_b64_tr_b16 v[154:155], v23 offset:2048
buffer_load_dwordx4 a[80:83], v254, s[16:19], s94 offen offset:0 sc1
v_mfma_f32_16x16x32_bf16 v[80:83], v[188:191], v[196:199], v[80:83]
v_mfma_f32_16x16x32_bf16 v[84:87], v[188:191], v[200:203], v[84:87]
v_mfma_f32_16x16x32_bf16 v[88:91], v[192:195], v[196:199], v[88:91]
v_mfma_f32_16x16x32_bf16 v[92:95], v[192:195], v[200:203], v[92:95]
s_waitcnt lgkmcnt(0)
v_mfma_f32_16x16x32_bf16 v[32:35], v[124:127], v[156:159], v[32:35]
ds_read_b128 v[196:199], v25 offset:0
v_mfma_f32_16x16x32_bf16 v[36:39], v[124:127], v[160:163], v[36:39]
ds_read_b128 v[200:203], v25 offset:2048
buffer_load_dwordx4 a[84:87], v254, s[16:19], s94 offen offset:1024 sc1
v_mfma_f32_16x16x32_bf16 v[96:99], v[124:127], v[120:123], v[96:99]
ds_read_b64_tr_b16 v[164:165], v16 offset:8192
v_mfma_f32_16x16x32_bf16 v[40:43], v[128:131], v[156:159], v[40:43]
ds_read_b64_tr_b16 v[166:167], v16 offset:10240
buffer_load_dwordx4 a[88:91], v254, s[16:19], s94 offen offset:2048 sc1
v_mfma_f32_16x16x32_bf16 v[44:47], v[128:131], v[160:163], v[44:47]
ds_read_b64_tr_b16 v[168:169], v17 offset:8192
v_mfma_f32_16x16x32_bf16 v[100:103], v[128:131], v[120:123], v[100:103]
ds_read_b64_tr_b16 v[170:171], v17 offset:10240
v_mfma_f32_16x16x32_bf16 v[48:51], v[132:135], v[156:159], v[48:51]
ds_read_b64_tr_b16 v[172:173], v18 offset:8192
buffer_load_dwordx4 a[92:95], v254, s[16:19], s94 offen offset:3072 sc1
v_add_u32 v254, 4096, v254
v_mfma_f32_16x16x32_bf16 v[52:55], v[132:135], v[160:163], v[52:55]
ds_read_b64_tr_b16 v[174:175], v18 offset:10240
v_mfma_f32_16x16x32_bf16 v[104:107], v[120:123], v[156:159], v[104:107]
ds_read_b64_tr_b16 v[176:177], v19 offset:8192
v_mfma_f32_16x16x32_bf16 v[56:59], v[136:139], v[156:159], v[56:59]
ds_read_b64_tr_b16 v[178:179], v19 offset:10240
buffer_load_dwordx4 a[96:99], v254, s[16:19], s94 offen offset:0 sc1
v_mfma_f32_16x16x32_bf16 v[60:63], v[136:139], v[160:163], v[60:63]
ds_read_b64_tr_b16 v[180:181], v20 offset:8192
v_mfma_f32_16x16x32_bf16 v[108:111], v[120:123], v[160:163], v[108:111]
ds_read_b64_tr_b16 v[182:183], v20 offset:10240
buffer_load_dwordx4 a[100:103], v254, s[16:19], s94 offen offset:1024 sc1
v_mfma_f32_16x16x32_bf16 v[64:67], v[140:143], v[156:159], v[64:67]
ds_read_b64_tr_b16 v[184:185], v21 offset:8192
v_mfma_f32_16x16x32_bf16 v[68:71], v[140:143], v[160:163], v[68:71]
ds_read_b64_tr_b16 v[186:187], v21 offset:10240
v_mfma_f32_16x16x32_bf16 v[112:115], v[156:159], v[156:159], v[112:115]
ds_read_b64_tr_b16 v[188:189], v22 offset:8192
buffer_load_dwordx4 a[104:107], v254, s[16:19], s94 offen offset:2048 sc1
v_mfma_f32_16x16x32_bf16 v[72:75], v[144:147], v[156:159], v[72:75]
ds_read_b64_tr_b16 v[190:191], v22 offset:10240
v_mfma_f32_16x16x32_bf16 v[76:79], v[144:147], v[160:163], v[76:79]
ds_read_b64_tr_b16 v[192:193], v23 offset:8192
v_mfma_f32_16x16x32_bf16 v[116:119], v[160:163], v[160:163], v[116:119]
ds_read_b64_tr_b16 v[194:195], v23 offset:10240
buffer_load_dwordx4 a[108:111], v254, s[16:19], s94 offen offset:3072 sc1
v_add_u32 v254, 4096, v254
v_mfma_f32_16x16x32_bf16 v[80:83], v[148:151], v[156:159], v[80:83]
v_mfma_f32_16x16x32_bf16 v[84:87], v[148:151], v[160:163], v[84:87]
v_mfma_f32_16x16x32_bf16 v[88:91], v[152:155], v[156:159], v[88:91]
v_mfma_f32_16x16x32_bf16 v[92:95], v[152:155], v[160:163], v[92:95]
s_waitcnt lgkmcnt(0)
s_barrier
v_mfma_f32_16x16x32_bf16 v[32:35], v[164:167], v[196:199], v[32:35]
v_mfma_f32_16x16x32_bf16 v[36:39], v[164:167], v[200:203], v[36:39]
buffer_load_dwordx4 a[112:115], v254, s[16:19], s94 offen offset:0 sc1
v_mfma_f32_16x16x32_bf16 v[96:99], v[164:167], v[120:123], v[96:99]
v_mfma_f32_16x16x32_bf16 v[40:43], v[168:171], v[196:199], v[40:43]
buffer_load_dwordx4 a[116:119], v254, s[16:19], s94 offen offset:1024 sc1
v_mfma_f32_16x16x32_bf16 v[44:47], v[168:171], v[200:203], v[44:47]
v_mfma_f32_16x16x32_bf16 v[100:103], v[168:171], v[120:123], v[100:103]
v_mfma_f32_16x16x32_bf16 v[48:51], v[172:175], v[196:199], v[48:51]
buffer_load_dwordx4 a[120:123], v254, s[16:19], s94 offen offset:2048 sc1
v_mfma_f32_16x16x32_bf16 v[52:55], v[172:175], v[200:203], v[52:55]
v_mfma_f32_16x16x32_bf16 v[104:107], v[120:123], v[196:199], v[104:107]
v_mfma_f32_16x16x32_bf16 v[56:59], v[176:179], v[196:199], v[56:59]
buffer_load_dwordx4 a[124:127], v254, s[16:19], s94 offen offset:3072 sc1
v_add_u32 v254, 4096, v254
v_mfma_f32_16x16x32_bf16 v[60:63], v[176:179], v[200:203], v[60:63]
v_mfma_f32_16x16x32_bf16 v[108:111], v[120:123], v[200:203], v[108:111]
buffer_load_dwordx4 a[128:131], v254, s[16:19], s94 offen offset:0 sc1
v_mfma_f32_16x16x32_bf16 v[64:67], v[180:183], v[196:199], v[64:67]
v_mfma_f32_16x16x32_bf16 v[68:71], v[180:183], v[200:203], v[68:71]
v_mfma_f32_16x16x32_bf16 v[112:115], v[196:199], v[196:199], v[112:115]
buffer_load_dwordx4 a[132:135], v254, s[16:19], s94 offen offset:1024 sc1
v_mfma_f32_16x16x32_bf16 v[72:75], v[184:187], v[196:199], v[72:75]
v_mfma_f32_16x16x32_bf16 v[76:79], v[184:187], v[200:203], v[76:79]
v_mfma_f32_16x16x32_bf16 v[116:119], v[200:203], v[200:203], v[116:119]
buffer_load_dwordx4 a[136:139], v254, s[16:19], s94 offen offset:2048 sc1
v_mfma_f32_16x16x32_bf16 v[80:83], v[188:191], v[196:199], v[80:83]
v_mfma_f32_16x16x32_bf16 v[84:87], v[188:191], v[200:203], v[84:87]
v_mfma_f32_16x16x32_bf16 v[88:91], v[192:195], v[196:199], v[88:91]
v_mfma_f32_16x16x32_bf16 v[92:95], v[192:195], v[200:203], v[92:95]
s_nop 7
s_nop 7
s_lshl_b32 s62, s24, 7
s_add_u32 s62, s62, 131072
v_lshl_add_u32 v5, v2, 4, s62
ds_write_b128 v5, v[96:99]
ds_write_b128 v5, v[100:103] offset:64
v_cndmask_b32 v204, v112, v113, s[50:51]
v_cndmask_b32 v204, v204, v114, s[52:53]
v_cndmask_b32 v204, v204, v115, s[54:55]
v_cndmask_b32 v205, v116, v117, s[50:51]
v_cndmask_b32 v205, v205, v118, s[52:53]
v_cndmask_b32 v205, v205, v119, s[54:55]
buffer_load_dwordx4 a[140:143], v254, s[16:19], s94 offen offset:3072 sc1
v_add_u32 v254, 4096, v254
ds_bpermute_b32 v206, v215, v204
ds_bpermute_b32 v207, v215, v205
s_waitcnt lgkmcnt(0)
v_mul_f32 v208, 0x3acccccd, v104
v_mul_f32 v206, 0x3acccccd, v206
v_fma_f32 v206, -v208, v208, v206
buffer_load_dwordx4 a[144:147], v254, s[16:19], s94 offen offset:0 sc1
v_max_f32 v206, 0, v206
v_cvt_pk_bf16_f32 v210, v208, v206
v_lshlrev_b32 v216, 16, v210
v_and_b32 v210, 0xffff0000, v210
v_add_f32 v210, 0x3727c5ac, v210
v_cvt_pk_bf16_f32 v210, v210, v210
buffer_load_dwordx4 a[148:151], v254, s[16:19], s94 offen offset:1024 sc1
v_and_b32 v210, 0xffff0000, v210
v_sqrt_f32 v210, v210
s_nop 0
v_cvt_pk_bf16_f32 v210, v210, v210
v_and_b32 v210, 0xffff0000, v210
v_rcp_f32 v218, v210
buffer_load_dwordx4 a[152:155], v254, s[16:19], s94 offen offset:2048 sc1
v_mul_f32 v209, 0x3acccccd, v108
v_mul_f32 v207, 0x3acccccd, v207
v_fma_f32 v207, -v209, v209, v207
v_max_f32 v207, 0, v207
v_cvt_pk_bf16_f32 v211, v209, v207
v_lshlrev_b32 v217, 16, v211
buffer_load_dwordx4 a[156:159], v254, s[16:19], s94 offen offset:3072 sc1
v_add_u32 v254, 4096, v254
v_and_b32 v211, 0xffff0000, v211
v_add_f32 v211, 0x3727c5ac, v211
v_cvt_pk_bf16_f32 v211, v211, v211
v_and_b32 v211, 0xffff0000, v211
v_sqrt_f32 v211, v211
s_nop 0
buffer_load_dwordx4 a[160:163], v254, s[16:19], s94 offen offset:0 sc1
v_cvt_pk_bf16_f32 v211, v211, v211
v_and_b32 v211, 0xffff0000, v211
v_rcp_f32 v219, v211
s_nop 0
v_mul_f32 v218, 0xbfb8aa3b, v218
v_mul_f32 v219, 0xbfb8aa3b, v219
buffer_load_dwordx4 a[164:167], v254, s[16:19], s94 offen offset:1024 sc1
s_waitcnt lgkmcnt(0)
s_barrier
s_lshl_b32 s62, s24, 1
s_add_u32 s62, s62, 0
s_and_b32 s62, s62, 7
s_lshl_b32 s62, s62, 6
buffer_load_dwordx4 a[168:171], v254, s[16:19], s94 offen offset:2048 sc1
s_add_u32 s62, s62, 131072
v_lshl_add_u32 v5, v2, 4, s62
ds_read_b128 v[124:127], v5
s_lshl_b32 s62, s24, 1
s_add_u32 s62, s62, 1
s_and_b32 s62, s62, 7
buffer_load_dwordx4 a[172:175], v254, s[16:19], s94 offen offset:3072 sc1
v_add_u32 v254, 4096, v254
s_lshl_b32 s62, s62, 6
s_add_u32 s62, s62, 131072
v_lshl_add_u32 v5, v2, 4, s62
ds_read_b128 v[128:131], v5
s_lshl_b32 s62, s24, 1
s_add_u32 s62, s62, 2
buffer_load_dwordx4 a[176:179], v254, s[16:19], s94 offen offset:0 sc1
s_and_b32 s62, s62, 7
s_lshl_b32 s62, s62, 6
s_add_u32 s62, s62, 131072
v_lshl_add_u32 v5, v2, 4, s62
ds_read_b128 v[132:135], v5
s_lshl_b32 s62, s24, 1
buffer_load_dwordx4 a[180:183], v254, s[16:19], s94 offen offset:1024 sc1
s_add_u32 s62, s62, 3
s_and_b32 s62, s62, 7
s_lshl_b32 s62, s62, 6
s_add_u32 s62, s62, 131072
v_lshl_add_u32 v5, v2, 4, s62
ds_read_b128 v[136:139], v5
buffer_load_dwordx4 a[184:187], v254, s[16:19], s94 offen offset:2048 sc1
s_lshl_b32 s62, s24, 1
s_add_u32 s62, s62, 4
s_and_b32 s62, s62, 7
s_lshl_b32 s62, s62, 6
s_add_u32 s62, s62, 131072
v_lshl_add_u32 v5, v2, 4, s62
buffer_load_dwordx4 a[188:191], v254, s[16:19], s94 offen offset:3072 sc1
v_add_u32 v254, 4096, v254
ds_read_b128 v[140:143], v5
s_lshl_b32 s62, s24, 1
s_add_u32 s62, s62, 5
s_and_b32 s62, s62, 7
s_lshl_b32 s62, s62, 6
s_add_u32 s62, s62, 131072
buffer_load_dwordx4 a[192:195], v254, s[16:19], s94 offen offset:0 sc1
v_lshl_add_u32 v5, v2, 4, s62
ds_read_b128 v[144:147], v5
s_lshl_b32 s62, s24, 1
s_add_u32 s62, s62, 6
s_and_b32 s62, s62, 7
s_lshl_b32 s62, s62, 6
buffer_load_dwordx4 a[196:199], v254, s[16:19], s94 offen offset:1024 sc1
s_add_u32 s62, s62, 131072
v_lshl_add_u32 v5, v2, 4, s62
ds_read_b128 v[148:151], v5
s_lshl_b32 s62, s24, 1
s_add_u32 s62, s62, 7
s_and_b32 s62, s62, 7
buffer_load_dwordx4 a[200:203], v254, s[16:19], s94 offen offset:2048 sc1
s_lshl_b32 s62, s62, 6
s_add_u32 s62, s62, 131072
v_lshl_add_u32 v5, v2, 4, s62
ds_read_b128 v[152:155], v5
s_mov_b32 s12, s86
s_mov_b32 s13, s87
buffer_load_dwordx4 a[204:207], v254, s[16:19], s94 offen offset:3072 sc1
v_add_u32 v254, 4096, v254
s_mov_b32 s14, 6291456
s_and_b32 s62, s60, 31
s_mul_i32 s62, s62, 48
s_lshl_b32 s63, s26, 2
s_add_u32 s62, s62, s63
s_lshl_b32 s62, s62, 2
s_lshr_b32 s63, s25, 3
s_lshl_b32 s63, s63, 1
s_add_u32 s62, s62, s63
s_lshl_b32 s62, s62, 10
v_lshlrev_b32 v6, 4, v0
s_waitcnt lgkmcnt(0)
s_add_u32 s63, s24, 0
s_and_b32 s63, s63, 3
s_lshl_b32 s63, s63, 12
s_add_u32 s63, s63, s62
v_fma_f32 v164, -v216, v124, v32
v_fma_f32 v165, -v216, v125, v33
v_fma_f32 v166, -v216, v126, v34
v_fma_f32 v167, -v216, v127, v35
v_fma_f32 v168, -v216, v128, v40
v_fma_f32 v169, -v216, v129, v41
v_fma_f32 v170, -v216, v130, v42
v_fma_f32 v171, -v216, v131, v43
v_pk_mul_f32 v[164:165], v[164:165], v[218:219] op_sel:[0,0] op_sel_hi:[1,0]
v_pk_mul_f32 v[166:167], v[166:167], v[218:219] op_sel:[0,0] op_sel_hi:[1,0]
v_pk_mul_f32 v[168:169], v[168:169], v[218:219] op_sel:[0,0] op_sel_hi:[1,0]
v_pk_mul_f32 v[170:171], v[170:171], v[218:219] op_sel:[0,0] op_sel_hi:[1,0]
v_exp_f32 v172, v164
v_exp_f32 v173, v165
v_exp_f32 v174, v166
v_exp_f32 v175, v167
v_exp_f32 v176, v168
v_exp_f32 v177, v169
v_exp_f32 v178, v170
v_exp_f32 v179, v171
v_pk_add_f32 v[172:173], v[172:173], 1.0 op_sel_hi:[1,0]
v_pk_add_f32 v[174:175], v[174:175], 1.0 op_sel_hi:[1,0]
v_pk_add_f32 v[176:177], v[176:177], 1.0 op_sel_hi:[1,0]
v_pk_add_f32 v[178:179], v[178:179], 1.0 op_sel_hi:[1,0]
v_rcp_f32 v172, v172
v_rcp_f32 v173, v173
v_rcp_f32 v174, v174
v_rcp_f32 v175, v175
v_rcp_f32 v176, v176
v_rcp_f32 v177, v177
v_rcp_f32 v178, v178
v_rcp_f32 v179, v179
v_pk_mul_f32 v[164:165], v[164:165], v[172:173]
v_pk_mul_f32 v[166:167], v[166:167], v[174:175]
v_pk_mul_f32 v[168:169], v[168:169], v[176:177]
v_pk_mul_f32 v[170:171], v[170:171], v[178:179]
v_cvt_pk_bf16_f32 v180, v164, v165
v_cvt_pk_bf16_f32 v181, v166, v167
v_cvt_pk_bf16_f32 v182, v168, v169
v_cvt_pk_bf16_f32 v183, v170, v171
buffer_store_dwordx4 v[180:183], v6, s[12:15], s63 offen offset:0 sc1
v_fma_f32 v184, -v217, v124, v36
v_fma_f32 v185, -v217, v125, v37
v_fma_f32 v186, -v217, v126, v38
v_fma_f32 v187, -v217, v127, v39
v_fma_f32 v188, -v217, v128, v44
v_fma_f32 v189, -v217, v129, v45
v_fma_f32 v190, -v217, v130, v46
v_fma_f32 v191, -v217, v131, v47
v_pk_mul_f32 v[184:185], v[184:185], v[218:219] op_sel:[0,1] op_sel_hi:[1,1]
v_pk_mul_f32 v[186:187], v[186:187], v[218:219] op_sel:[0,1] op_sel_hi:[1,1]
v_pk_mul_f32 v[188:189], v[188:189], v[218:219] op_sel:[0,1] op_sel_hi:[1,1]
v_pk_mul_f32 v[190:191], v[190:191], v[218:219] op_sel:[0,1] op_sel_hi:[1,1]
v_exp_f32 v192, v184
v_exp_f32 v193, v185
v_exp_f32 v194, v186
v_exp_f32 v195, v187
v_exp_f32 v196, v188
v_exp_f32 v197, v189
v_exp_f32 v198, v190
v_exp_f32 v199, v191
v_pk_add_f32 v[192:193], v[192:193], 1.0 op_sel_hi:[1,0]
v_pk_add_f32 v[194:195], v[194:195], 1.0 op_sel_hi:[1,0]
v_pk_add_f32 v[196:197], v[196:197], 1.0 op_sel_hi:[1,0]
v_pk_add_f32 v[198:199], v[198:199], 1.0 op_sel_hi:[1,0]
v_rcp_f32 v192, v192
v_rcp_f32 v193, v193
v_rcp_f32 v194, v194
v_rcp_f32 v195, v195
v_rcp_f32 v196, v196
v_rcp_f32 v197, v197
v_rcp_f32 v198, v198
v_rcp_f32 v199, v199
v_pk_mul_f32 v[184:185], v[184:185], v[192:193]
v_pk_mul_f32 v[186:187], v[186:187], v[194:195]
v_pk_mul_f32 v[188:189], v[188:189], v[196:197]
v_pk_mul_f32 v[190:191], v[190:191], v[198:199]
v_cvt_pk_bf16_f32 v200, v184, v185
v_cvt_pk_bf16_f32 v201, v186, v187
v_cvt_pk_bf16_f32 v202, v188, v189
v_cvt_pk_bf16_f32 v203, v190, v191
buffer_store_dwordx4 v[200:203], v6, s[12:15], s63 offen offset:1024 sc1
s_add_u32 s63, s24, 1
s_and_b32 s63, s63, 3
s_lshl_b32 s63, s63, 12
s_add_u32 s63, s63, s62
v_fma_f32 v164, -v216, v132, v48
v_fma_f32 v165, -v216, v133, v49
v_fma_f32 v166, -v216, v134, v50
v_fma_f32 v167, -v216, v135, v51
v_fma_f32 v168, -v216, v136, v56
v_fma_f32 v169, -v216, v137, v57
v_fma_f32 v170, -v216, v138, v58
v_fma_f32 v171, -v216, v139, v59
v_pk_mul_f32 v[164:165], v[164:165], v[218:219] op_sel:[0,0] op_sel_hi:[1,0]
v_pk_mul_f32 v[166:167], v[166:167], v[218:219] op_sel:[0,0] op_sel_hi:[1,0]
v_pk_mul_f32 v[168:169], v[168:169], v[218:219] op_sel:[0,0] op_sel_hi:[1,0]
v_pk_mul_f32 v[170:171], v[170:171], v[218:219] op_sel:[0,0] op_sel_hi:[1,0]
v_exp_f32 v172, v164
v_exp_f32 v173, v165
v_exp_f32 v174, v166
v_exp_f32 v175, v167
v_exp_f32 v176, v168
v_exp_f32 v177, v169
v_exp_f32 v178, v170
v_exp_f32 v179, v171
v_pk_add_f32 v[172:173], v[172:173], 1.0 op_sel_hi:[1,0]
v_pk_add_f32 v[174:175], v[174:175], 1.0 op_sel_hi:[1,0]
v_pk_add_f32 v[176:177], v[176:177], 1.0 op_sel_hi:[1,0]
v_pk_add_f32 v[178:179], v[178:179], 1.0 op_sel_hi:[1,0]
v_rcp_f32 v172, v172
v_rcp_f32 v173, v173
v_rcp_f32 v174, v174
v_rcp_f32 v175, v175
v_rcp_f32 v176, v176
v_rcp_f32 v177, v177
v_rcp_f32 v178, v178
v_rcp_f32 v179, v179
v_pk_mul_f32 v[164:165], v[164:165], v[172:173]
v_pk_mul_f32 v[166:167], v[166:167], v[174:175]
v_pk_mul_f32 v[168:169], v[168:169], v[176:177]
v_pk_mul_f32 v[170:171], v[170:171], v[178:179]
v_cvt_pk_bf16_f32 v180, v164, v165
v_cvt_pk_bf16_f32 v181, v166, v167
v_cvt_pk_bf16_f32 v182, v168, v169
v_cvt_pk_bf16_f32 v183, v170, v171
buffer_store_dwordx4 v[180:183], v6, s[12:15], s63 offen offset:0 sc1
v_fma_f32 v184, -v217, v132, v52
v_fma_f32 v185, -v217, v133, v53
v_fma_f32 v186, -v217, v134, v54
v_fma_f32 v187, -v217, v135, v55
v_fma_f32 v188, -v217, v136, v60
v_fma_f32 v189, -v217, v137, v61
v_fma_f32 v190, -v217, v138, v62
v_fma_f32 v191, -v217, v139, v63
v_pk_mul_f32 v[184:185], v[184:185], v[218:219] op_sel:[0,1] op_sel_hi:[1,1]
v_pk_mul_f32 v[186:187], v[186:187], v[218:219] op_sel:[0,1] op_sel_hi:[1,1]
v_pk_mul_f32 v[188:189], v[188:189], v[218:219] op_sel:[0,1] op_sel_hi:[1,1]
v_pk_mul_f32 v[190:191], v[190:191], v[218:219] op_sel:[0,1] op_sel_hi:[1,1]
v_exp_f32 v192, v184
v_exp_f32 v193, v185
v_exp_f32 v194, v186
v_exp_f32 v195, v187
v_exp_f32 v196, v188
v_exp_f32 v197, v189
v_exp_f32 v198, v190
v_exp_f32 v199, v191
v_pk_add_f32 v[192:193], v[192:193], 1.0 op_sel_hi:[1,0]
v_pk_add_f32 v[194:195], v[194:195], 1.0 op_sel_hi:[1,0]
v_pk_add_f32 v[196:197], v[196:197], 1.0 op_sel_hi:[1,0]
v_pk_add_f32 v[198:199], v[198:199], 1.0 op_sel_hi:[1,0]
v_rcp_f32 v192, v192
v_rcp_f32 v193, v193
v_rcp_f32 v194, v194
v_rcp_f32 v195, v195
v_rcp_f32 v196, v196
v_rcp_f32 v197, v197
v_rcp_f32 v198, v198
v_rcp_f32 v199, v199
v_pk_mul_f32 v[184:185], v[184:185], v[192:193]
v_pk_mul_f32 v[186:187], v[186:187], v[194:195]
v_pk_mul_f32 v[188:189], v[188:189], v[196:197]
v_pk_mul_f32 v[190:191], v[190:191], v[198:199]
v_cvt_pk_bf16_f32 v200, v184, v185
v_cvt_pk_bf16_f32 v201, v186, v187
v_cvt_pk_bf16_f32 v202, v188, v189
v_cvt_pk_bf16_f32 v203, v190, v191
buffer_store_dwordx4 v[200:203], v6, s[12:15], s63 offen offset:1024 sc1
s_add_u32 s63, s24, 2
s_and_b32 s63, s63, 3
s_lshl_b32 s63, s63, 12
s_add_u32 s63, s63, s62
v_fma_f32 v164, -v216, v140, v64
v_fma_f32 v165, -v216, v141, v65
v_fma_f32 v166, -v216, v142, v66
v_fma_f32 v167, -v216, v143, v67
v_fma_f32 v168, -v216, v144, v72
v_fma_f32 v169, -v216, v145, v73
v_fma_f32 v170, -v216, v146, v74
v_fma_f32 v171, -v216, v147, v75
v_pk_mul_f32 v[164:165], v[164:165], v[218:219] op_sel:[0,0] op_sel_hi:[1,0]
v_pk_mul_f32 v[166:167], v[166:167], v[218:219] op_sel:[0,0] op_sel_hi:[1,0]
v_pk_mul_f32 v[168:169], v[168:169], v[218:219] op_sel:[0,0] op_sel_hi:[1,0]
v_pk_mul_f32 v[170:171], v[170:171], v[218:219] op_sel:[0,0] op_sel_hi:[1,0]
v_exp_f32 v172, v164
v_exp_f32 v173, v165
v_exp_f32 v174, v166
v_exp_f32 v175, v167
v_exp_f32 v176, v168
v_exp_f32 v177, v169
v_exp_f32 v178, v170
v_exp_f32 v179, v171
v_pk_add_f32 v[172:173], v[172:173], 1.0 op_sel_hi:[1,0]
v_pk_add_f32 v[174:175], v[174:175], 1.0 op_sel_hi:[1,0]
v_pk_add_f32 v[176:177], v[176:177], 1.0 op_sel_hi:[1,0]
v_pk_add_f32 v[178:179], v[178:179], 1.0 op_sel_hi:[1,0]
v_rcp_f32 v172, v172
v_rcp_f32 v173, v173
v_rcp_f32 v174, v174
v_rcp_f32 v175, v175
v_rcp_f32 v176, v176
v_rcp_f32 v177, v177
v_rcp_f32 v178, v178
v_rcp_f32 v179, v179
v_pk_mul_f32 v[164:165], v[164:165], v[172:173]
v_pk_mul_f32 v[166:167], v[166:167], v[174:175]
v_pk_mul_f32 v[168:169], v[168:169], v[176:177]
v_pk_mul_f32 v[170:171], v[170:171], v[178:179]
v_cvt_pk_bf16_f32 v180, v164, v165
v_cvt_pk_bf16_f32 v181, v166, v167
v_cvt_pk_bf16_f32 v182, v168, v169
v_cvt_pk_bf16_f32 v183, v170, v171
buffer_store_dwordx4 v[180:183], v6, s[12:15], s63 offen offset:0 sc1
v_fma_f32 v184, -v217, v140, v68
v_fma_f32 v185, -v217, v141, v69
v_fma_f32 v186, -v217, v142, v70
v_fma_f32 v187, -v217, v143, v71
v_fma_f32 v188, -v217, v144, v76
v_fma_f32 v189, -v217, v145, v77
v_fma_f32 v190, -v217, v146, v78
v_fma_f32 v191, -v217, v147, v79
v_pk_mul_f32 v[184:185], v[184:185], v[218:219] op_sel:[0,1] op_sel_hi:[1,1]
v_pk_mul_f32 v[186:187], v[186:187], v[218:219] op_sel:[0,1] op_sel_hi:[1,1]
v_pk_mul_f32 v[188:189], v[188:189], v[218:219] op_sel:[0,1] op_sel_hi:[1,1]
v_pk_mul_f32 v[190:191], v[190:191], v[218:219] op_sel:[0,1] op_sel_hi:[1,1]
v_exp_f32 v192, v184
v_exp_f32 v193, v185
v_exp_f32 v194, v186
v_exp_f32 v195, v187
v_exp_f32 v196, v188
v_exp_f32 v197, v189
v_exp_f32 v198, v190
v_exp_f32 v199, v191
v_pk_add_f32 v[192:193], v[192:193], 1.0 op_sel_hi:[1,0]
v_pk_add_f32 v[194:195], v[194:195], 1.0 op_sel_hi:[1,0]
v_pk_add_f32 v[196:197], v[196:197], 1.0 op_sel_hi:[1,0]
v_pk_add_f32 v[198:199], v[198:199], 1.0 op_sel_hi:[1,0]
v_rcp_f32 v192, v192
v_rcp_f32 v193, v193
v_rcp_f32 v194, v194
v_rcp_f32 v195, v195
v_rcp_f32 v196, v196
v_rcp_f32 v197, v197
v_rcp_f32 v198, v198
v_rcp_f32 v199, v199
v_pk_mul_f32 v[184:185], v[184:185], v[192:193]
v_pk_mul_f32 v[186:187], v[186:187], v[194:195]
v_pk_mul_f32 v[188:189], v[188:189], v[196:197]
v_pk_mul_f32 v[190:191], v[190:191], v[198:199]
v_cvt_pk_bf16_f32 v200, v184, v185
v_cvt_pk_bf16_f32 v201, v186, v187
v_cvt_pk_bf16_f32 v202, v188, v189
v_cvt_pk_bf16_f32 v203, v190, v191
buffer_store_dwordx4 v[200:203], v6, s[12:15], s63 offen offset:1024 sc1
s_add_u32 s63, s24, 3
s_and_b32 s63, s63, 3
s_lshl_b32 s63, s63, 12
s_add_u32 s63, s63, s62
v_fma_f32 v164, -v216, v148, v80
v_fma_f32 v165, -v216, v149, v81
v_fma_f32 v166, -v216, v150, v82
v_fma_f32 v167, -v216, v151, v83
v_fma_f32 v168, -v216, v152, v88
v_fma_f32 v169, -v216, v153, v89
v_fma_f32 v170, -v216, v154, v90
v_fma_f32 v171, -v216, v155, v91
v_pk_mul_f32 v[164:165], v[164:165], v[218:219] op_sel:[0,0] op_sel_hi:[1,0]
v_pk_mul_f32 v[166:167], v[166:167], v[218:219] op_sel:[0,0] op_sel_hi:[1,0]
v_pk_mul_f32 v[168:169], v[168:169], v[218:219] op_sel:[0,0] op_sel_hi:[1,0]
v_pk_mul_f32 v[170:171], v[170:171], v[218:219] op_sel:[0,0] op_sel_hi:[1,0]
v_exp_f32 v172, v164
v_exp_f32 v173, v165
v_exp_f32 v174, v166
v_exp_f32 v175, v167
v_exp_f32 v176, v168
v_exp_f32 v177, v169
v_exp_f32 v178, v170
v_exp_f32 v179, v171
v_pk_add_f32 v[172:173], v[172:173], 1.0 op_sel_hi:[1,0]
v_pk_add_f32 v[174:175], v[174:175], 1.0 op_sel_hi:[1,0]
v_pk_add_f32 v[176:177], v[176:177], 1.0 op_sel_hi:[1,0]
v_pk_add_f32 v[178:179], v[178:179], 1.0 op_sel_hi:[1,0]
v_rcp_f32 v172, v172
v_rcp_f32 v173, v173
v_rcp_f32 v174, v174
v_rcp_f32 v175, v175
v_rcp_f32 v176, v176
v_rcp_f32 v177, v177
v_rcp_f32 v178, v178
v_rcp_f32 v179, v179
v_pk_mul_f32 v[164:165], v[164:165], v[172:173]
v_pk_mul_f32 v[166:167], v[166:167], v[174:175]
v_pk_mul_f32 v[168:169], v[168:169], v[176:177]
v_pk_mul_f32 v[170:171], v[170:171], v[178:179]
v_cvt_pk_bf16_f32 v180, v164, v165
v_cvt_pk_bf16_f32 v181, v166, v167
v_cvt_pk_bf16_f32 v182, v168, v169
v_cvt_pk_bf16_f32 v183, v170, v171
buffer_store_dwordx4 v[180:183], v6, s[12:15], s63 offen offset:0 sc1
v_fma_f32 v184, -v217, v148, v84
v_fma_f32 v185, -v217, v149, v85
v_fma_f32 v186, -v217, v150, v86
v_fma_f32 v187, -v217, v151, v87
v_fma_f32 v188, -v217, v152, v92
v_fma_f32 v189, -v217, v153, v93
v_fma_f32 v190, -v217, v154, v94
v_fma_f32 v191, -v217, v155, v95
v_pk_mul_f32 v[184:185], v[184:185], v[218:219] op_sel:[0,1] op_sel_hi:[1,1]
v_pk_mul_f32 v[186:187], v[186:187], v[218:219] op_sel:[0,1] op_sel_hi:[1,1]
v_pk_mul_f32 v[188:189], v[188:189], v[218:219] op_sel:[0,1] op_sel_hi:[1,1]
v_pk_mul_f32 v[190:191], v[190:191], v[218:219] op_sel:[0,1] op_sel_hi:[1,1]
v_exp_f32 v192, v184
v_exp_f32 v193, v185
v_exp_f32 v194, v186
v_exp_f32 v195, v187
v_exp_f32 v196, v188
v_exp_f32 v197, v189
v_exp_f32 v198, v190
v_exp_f32 v199, v191
v_pk_add_f32 v[192:193], v[192:193], 1.0 op_sel_hi:[1,0]
v_pk_add_f32 v[194:195], v[194:195], 1.0 op_sel_hi:[1,0]
v_pk_add_f32 v[196:197], v[196:197], 1.0 op_sel_hi:[1,0]
v_pk_add_f32 v[198:199], v[198:199], 1.0 op_sel_hi:[1,0]
v_rcp_f32 v192, v192
v_rcp_f32 v193, v193
v_rcp_f32 v194, v194
v_rcp_f32 v195, v195
v_rcp_f32 v196, v196
v_rcp_f32 v197, v197
v_rcp_f32 v198, v198
v_rcp_f32 v199, v199
v_pk_mul_f32 v[184:185], v[184:185], v[192:193]
v_pk_mul_f32 v[186:187], v[186:187], v[194:195]
v_pk_mul_f32 v[188:189], v[188:189], v[196:197]
v_pk_mul_f32 v[190:191], v[190:191], v[198:199]
v_cvt_pk_bf16_f32 v200, v184, v185
v_cvt_pk_bf16_f32 v201, v186, v187
v_cvt_pk_bf16_f32 v202, v188, v189
v_cvt_pk_bf16_f32 v203, v190, v191
buffer_store_dwordx4 v[200:203], v6, s[12:15], s63 offen offset:1024 sc1
s_mul_i32 s56, s26, 22
s_lshr_b32 s56, s56, 6
s_mul_i32 s57, s56, 3
s_sub_u32 s57, s26, s57
s_lshl_b32 s57, s57, 1
s_lshr_b32 s62, s25, 3
s_add_u32 s57, s57, s62
s_lshl_b32 s57, s57, 4
s_lshl_b32 s56, s56, 7
s_add_u32 s57, s57, s56
s_and_b32 s56, s25, 7
s_lshl_b32 s56, s56, 9
s_add_u32 s57, s57, s56
s_add_u32 s93, s57, 11534336
s_sub_u32 s56, 32, s90
s_and_b32 s56, s56, 31
s_mul_i32 s57, s91, 20
s_sub_u32 s58, 140, s57
s_cmp_ge_u32 s91, 4
s_cselect_b32 s27, 1, 0
s_cselect_b32 s28, s56, s90
s_cselect_b32 s29, s58, s57
s_and_b32 s56, s24, 1
s_lshl_b32 s56, s56, 10
s_lshr_b32 s57, s24, 1
s_lshl_b32 s57, s57, 5
s_add_u32 s30, s56, s57
s_add_u32 s30, s30, s90
s_mov_b32 s4, s86
s_mov_b32 s5, s87
s_mov_b32 s6, 6291456
s_mov_b32 s8, s86
s_mov_b32 s9, s87
s_add_u32 s8, s8, 6291456
s_addc_u32 s9, s9, 0
s_mov_b32 s10, 2621440
v_mov_b32 v7, 81920
v_mul_u32_u24 v13, v7, v1
v_lshl_add_u32 v13, v2, 3, v13
s_mul_i32 s31, s30, 1280
s_mul_i32 s56, s91, 160
s_add_u32 s31, s31, s56
s_mul_i32 s32, s28, 81920
s_mul_i32 s56, s24, 448
v_add_u32 v5, s56, v0
s_movk_i32 s35, 20160
v_add_u32 v6, 0, v5
v_mul_u32_u24 v7, 2341, v6
v_lshrrev_b32 v7, 16, v7
v_mul_u32_u24 v3, 28, v7
v_sub_u32 v6, v6, v3
v_add_u32 v6, s29, v6
v_subrev_u32 v3, 80, v6
v_cmp_le_u32 vcc, 80, v6
v_lshlrev_b32 v4, 8, v7
v_cndmask_b32 v6, v6, v3, vcc
v_lshl_add_u32 v4, v7, 6, v4
v_mul_u32_u24 v3, 205, v6
v_lshrrev_b32 v3, 12, v3
v_mad_u32_u24 v4, v3, s35, v4
v_lshl_add_u32 v16, v6, 4, v4
v_add_u32 v6, 64, v5
v_mul_u32_u24 v7, 2341, v6
v_lshrrev_b32 v7, 16, v7
v_mul_u32_u24 v3, 28, v7
v_sub_u32 v6, v6, v3
v_add_u32 v6, s29, v6
v_subrev_u32 v3, 80, v6
v_cmp_le_u32 vcc, 80, v6
v_lshlrev_b32 v4, 8, v7
v_cndmask_b32 v6, v6, v3, vcc
v_lshl_add_u32 v4, v7, 6, v4
v_mul_u32_u24 v3, 205, v6
v_lshrrev_b32 v3, 12, v3
v_mad_u32_u24 v4, v3, s35, v4
v_lshl_add_u32 v20, v6, 4, v4
v_add_u32 v6, 128, v5
v_mul_u32_u24 v7, 2341, v6
v_lshrrev_b32 v7, 16, v7
v_mul_u32_u24 v3, 28, v7
v_sub_u32 v6, v6, v3
v_add_u32 v6, s29, v6
v_subrev_u32 v3, 80, v6
v_cmp_le_u32 vcc, 80, v6
v_lshlrev_b32 v4, 8, v7
v_cndmask_b32 v6, v6, v3, vcc
v_lshl_add_u32 v4, v7, 6, v4
v_mul_u32_u24 v3, 205, v6
v_lshrrev_b32 v3, 12, v3
v_mad_u32_u24 v4, v3, s35, v4
v_lshl_add_u32 v24, v6, 4, v4
v_add_u32 v6, 192, v5
v_mul_u32_u24 v7, 2341, v6
v_lshrrev_b32 v7, 16, v7
v_mul_u32_u24 v3, 28, v7
v_sub_u32 v6, v6, v3
v_add_u32 v6, s29, v6
v_subrev_u32 v3, 80, v6
v_cmp_le_u32 vcc, 80, v6
v_lshlrev_b32 v4, 8, v7
v_cndmask_b32 v6, v6, v3, vcc
v_lshl_add_u32 v4, v7, 6, v4
v_mul_u32_u24 v3, 205, v6
v_lshrrev_b32 v3, 12, v3
v_mad_u32_u24 v4, v3, s35, v4
v_lshl_add_u32 v28, v6, 4, v4
v_add_u32 v6, 256, v5
v_mul_u32_u24 v7, 2341, v6
v_lshrrev_b32 v7, 16, v7
v_mul_u32_u24 v3, 28, v7
v_sub_u32 v6, v6, v3
v_add_u32 v6, s29, v6
v_subrev_u32 v3, 80, v6
v_cmp_le_u32 vcc, 80, v6
v_lshlrev_b32 v4, 8, v7
v_cndmask_b32 v6, v6, v3, vcc
v_lshl_add_u32 v4, v7, 6, v4
v_mul_u32_u24 v3, 205, v6
v_lshrrev_b32 v3, 12, v3
v_mad_u32_u24 v4, v3, s35, v4
v_lshl_add_u32 v32, v6, 4, v4
v_add_u32 v6, 320, v5
v_mul_u32_u24 v7, 2341, v6
v_lshrrev_b32 v7, 16, v7
v_mul_u32_u24 v3, 28, v7
v_sub_u32 v6, v6, v3
v_add_u32 v6, s29, v6
v_subrev_u32 v3, 80, v6
v_cmp_le_u32 vcc, 80, v6
v_lshlrev_b32 v4, 8, v7
v_cndmask_b32 v6, v6, v3, vcc
v_lshl_add_u32 v4, v7, 6, v4
v_mul_u32_u24 v3, 205, v6
v_lshrrev_b32 v3, 12, v3
v_mad_u32_u24 v4, v3, s35, v4
v_lshl_add_u32 v36, v6, 4, v4
v_add_u32 v6, 384, v5
v_mul_u32_u24 v7, 2341, v6
v_lshrrev_b32 v7, 16, v7
v_mul_u32_u24 v3, 28, v7
v_sub_u32 v6, v6, v3
v_add_u32 v6, s29, v6
v_subrev_u32 v3, 80, v6
v_cmp_le_u32 vcc, 80, v6
v_lshlrev_b32 v4, 8, v7
v_cndmask_b32 v6, v6, v3, vcc
v_lshl_add_u32 v4, v7, 6, v4
v_mul_u32_u24 v3, 205, v6
v_lshrrev_b32 v3, 12, v3
v_mad_u32_u24 v4, v3, s35, v4
v_lshl_add_u32 v248, v6, 4, v4
s_add_u32 s56, s24, 0
s_and_b32 s56, s56, 3
s_lshl_b32 s56, s56, 10
v_lshl_add_u32 v8, v0, 4, s56
s_add_u32 s56, s24, 1
s_and_b32 s56, s56, 3
s_lshl_b32 s56, s56, 10
v_lshl_add_u32 v9, v0, 4, s56
s_add_u32 s56, s24, 2
s_and_b32 s56, s56, 3
s_lshl_b32 s56, s56, 10
v_lshl_add_u32 v10, v0, 4, s56
s_add_u32 s56, s24, 3
s_and_b32 s56, s56, 3
s_lshl_b32 s56, s56, 10
v_lshl_add_u32 v11, v0, 4, s56
s_mul_i32 s34, s90, 48
s_mul_i32 s56, s24, 12
s_add_u32 s34, s34, s56
s_lshl_b32 s34, s34, 12
v_lshrrev_b32 v5, 2, v1
v_lshrrev_b32 v6, 1, v2
v_lshl_add_u32 v5, v6, 3, v5
v_mul_u32_u24 v5, 448, v5
v_and_b32 v6, 3, v1
v_lshl_add_u32 v5, v6, 4, v5
v_and_b32 v6, 1, v2
v_lshl_add_u32 v5, v6, 3, v5
v_add_u32 v12, 102400, v5
s_lshr_b32 s56, s90, 2
s_lshl_b32 s56, s56, 9
s_lshl_b32 s57, s24, 7
s_add_u32 s56, s56, s57
s_add_u32 s56, s56, 11534336
v_lshl_add_u32 v14, v0, 4, s56
s_mov_b32 s56, 11538432
v_lshl_add_u32 v15, v0, 4, s56
s_cmp_eq_u32 s27, 0
s_cselect_b32 s33, 0x80008000, 0
s_or_b32 s92, s2, s24
s_waitcnt vmcnt(0)
s_barrier
s_cmp_lg_u32 s24, 0
s_cbranch_scc1 G1_pubd
v_mov_b32 v5, s93
v_mov_b32 v6, s65
s_mov_b64 exec, 1
global_store_dword v5, v6, s[86:87] sc1
s_mov_b64 exec, -1
G1_pubd:
v_lshlrev_b32 v5, 6, v1
v_add_u32 v5, s30, v5
v_lshlrev_b32 v5, 12, v5
v_lshrrev_b32 v6, 1, v2
v_lshl_add_u32 v5, v6, 4, v5
v_and_b32 v6, 1, v2
v_cmp_eq_u32 vcc, 0, v6
s_nop 1
s_mov_b64 exec, vcc
global_load_dwordx4 a[240:243], v5, s[38:39] offset:0
global_load_dwordx4 a[244:247], v5, s[38:39] offset:32
global_load_dwordx4 a[248:251], v5, s[38:39] offset:64
global_load_dwordx4 a[252:255], v5, s[38:39] offset:96
s_not_b64 exec, exec
global_load_dwordx4 a[240:243], v5, s[40:41] offset:0
global_load_dwordx4 a[244:247], v5, s[40:41] offset:32
global_load_dwordx4 a[248:251], v5, s[40:41] offset:64
global_load_dwordx4 a[252:255], v5, s[40:41] offset:96
s_mov_b64 exec, -1
buffer_load_dwordx4 a[208:211], v254, s[16:19], s94 offen offset:0 sc1
buffer_load_dwordx4 a[212:215], v254, s[16:19], s94 offen offset:1024 sc1
buffer_load_dwordx4 a[216:219], v254, s[16:19], s94 offen offset:2048 sc1
buffer_load_dwordx4 a[220:223], v254, s[16:19], s94 offen offset:3072 sc1
v_add_u32 v254, 4096, v254
buffer_load_dwordx4 a[224:227], v254, s[16:19], s94 offen offset:0 sc1
buffer_load_dwordx4 a[228:231], v254, s[16:19], s94 offen offset:1024 sc1
buffer_load_dwordx4 a[232:235], v254, s[16:19], s94 offen offset:2048 sc1
buffer_load_dwordx4 a[236:239], v254, s[16:19], s94 offen offset:3072 sc1
v_add_u32 v254, 4096, v254
s_branch K2_start
G1_wsp:
s_mov_b32 s62, 0
s_mov_b64 exec, 0x3fffffff
G1_wsp1:
global_load_dword v30, v29, s[86:87] sc1
s_waitcnt vmcnt(0)
v_cmp_ne_u32 vcc, s65, v30
s_add_u32 s62, s62, 1
s_nop 1
s_cbranch_vccz G1_wsp2
s_cmp_lt_u32 s62, 200000
s_cbranch_scc1 G1_wsp1
G1_wsp2:
s_mov_b64 exec, -1
s_branch G1_wok
G1_sig:
v_mov_b32 v5, s93
v_mov_b32 v6, s65
s_mov_b64 exec, 1
global_store_dword v5, v6, s[86:87] sc1
s_mov_b64 exec, -1
s_branch G1_sigd
DF_wsp:
s_mov_b32 s62, 0
s_mov_b64 exec, 0x3fffffff
DF_wsp1:
global_load_dword v252, v253, s[86:87] sc1
s_waitcnt vmcnt(0)
v_cmp_ne_u32 vcc, s65, v252
s_add_u32 s62, s62, 1
s_nop 1
s_cbranch_vccz DF_wsp2
s_cmp_lt_u32 s62, 200000
s_cbranch_scc1 DF_wsp1
DF_wsp2:
s_mov_b64 exec, -1
s_branch DF_wok
K2_late:
s_waitcnt vmcnt(21)
v_mfma_f32_16x16x32_bf16 v[40:43], a[120:123], v[216:219], v[40:43]
v_mfma_f32_16x16x32_bf16 v[60:63], a[120:123], v[220:223], v[60:63]
v_mfma_f32_16x16x32_bf16 v[80:83], a[120:123], v[224:227], v[80:83]
v_mfma_f32_16x16x32_bf16 v[100:103], a[120:123], v[228:231], v[100:103]
v_mfma_f32_16x16x32_bf16 v[44:47], a[124:127], v[216:219], v[44:47]
v_mfma_f32_16x16x32_bf16 v[64:67], a[124:127], v[220:223], v[64:67]
v_mfma_f32_16x16x32_bf16 v[84:87], a[124:127], v[224:227], v[84:87]
v_mfma_f32_16x16x32_bf16 v[104:107], a[124:127], v[228:231], v[104:107]
v_mfma_f32_16x16x32_bf16 v[48:51], a[128:131], v[216:219], v[48:51]
v_mfma_f32_16x16x32_bf16 v[68:71], a[128:131], v[220:223], v[68:71]
v_mfma_f32_16x16x32_bf16 v[88:91], a[128:131], v[224:227], v[88:91]
v_mfma_f32_16x16x32_bf16 v[108:111], a[128:131], v[228:231], v[108:111]
v_mfma_f32_16x16x32_bf16 v[52:55], a[132:135], v[216:219], v[52:55]
v_mfma_f32_16x16x32_bf16 v[72:75], a[132:135], v[220:223], v[72:75]
v_mfma_f32_16x16x32_bf16 v[92:95], a[132:135], v[224:227], v[92:95]
v_mfma_f32_16x16x32_bf16 v[112:115], a[132:135], v[228:231], v[112:115]
v_mfma_f32_16x16x32_bf16 v[56:59], a[136:139], v[216:219], v[56:59]
v_mfma_f32_16x16x32_bf16 v[76:79], a[136:139], v[220:223], v[76:79]
v_mfma_f32_16x16x32_bf16 v[96:99], a[136:139], v[224:227], v[96:99]
v_mfma_f32_16x16x32_bf16 v[116:119], a[136:139], v[228:231], v[116:119]
s_waitcnt vmcnt(17)
v_mfma_f32_16x16x32_bf16 v[40:43], a[140:143], v[232:235], v[40:43]
v_mfma_f32_16x16x32_bf16 v[60:63], a[140:143], v[236:239], v[60:63]
v_mfma_f32_16x16x32_bf16 v[80:83], a[140:143], v[240:243], v[80:83]
v_mfma_f32_16x16x32_bf16 v[100:103], a[140:143], v[244:247], v[100:103]
v_mfma_f32_16x16x32_bf16 v[44:47], a[144:147], v[232:235], v[44:47]
v_mfma_f32_16x16x32_bf16 v[64:67], a[144:147], v[236:239], v[64:67]
v_mfma_f32_16x16x32_bf16 v[84:87], a[144:147], v[240:243], v[84:87]
v_mfma_f32_16x16x32_bf16 v[104:107], a[144:147], v[244:247], v[104:107]
v_mfma_f32_16x16x32_bf16 v[48:51], a[148:151], v[232:235], v[48:51]
v_mfma_f32_16x16x32_bf16 v[68:71], a[148:151], v[236:239], v[68:71]
v_mfma_f32_16x16x32_bf16 v[88:91], a[148:151], v[240:243], v[88:91]
v_mfma_f32_16x16x32_bf16 v[108:111], a[148:151], v[244:247], v[108:111]
v_mfma_f32_16x16x32_bf16 v[52:55], a[152:155], v[232:235], v[52:55]
v_mfma_f32_16x16x32_bf16 v[72:75], a[152:155], v[236:239], v[72:75]
v_mfma_f32_16x16x32_bf16 v[92:95], a[152:155], v[240:243], v[92:95]
v_mfma_f32_16x16x32_bf16 v[112:115], a[152:155], v[244:247], v[112:115]
v_mfma_f32_16x16x32_bf16 v[56:59], a[156:159], v[232:235], v[56:59]
v_mfma_f32_16x16x32_bf16 v[76:79], a[156:159], v[236:239], v[76:79]
v_mfma_f32_16x16x32_bf16 v[96:99], a[156:159], v[240:243], v[96:99]
v_mfma_f32_16x16x32_bf16 v[116:119], a[156:159], v[244:247], v[116:119]
s_mov_b32 s12, s36
s_mov_b32 s13, s37
s_mov_b32 s14, 2621440
s_waitcnt vmcnt(13)
v_mfma_f32_16x16x32_bf16 v[40:43], a[160:163], v[120:123], v[40:43]
v_mfma_f32_16x16x32_bf16 v[60:63], a[160:163], v[124:127], v[60:63]
buffer_load_dwordx2 v[232:233], v13, s[12:15], s31 offen offset:0
v_mfma_f32_16x16x32_bf16 v[80:83], a[160:163], v[128:131], v[80:83]
buffer_load_dwordx2 v[234:235], v13, s[12:15], s31 offen offset:32
v_mfma_f32_16x16x32_bf16 v[100:103], a[160:163], v[132:135], v[100:103]
buffer_load_dwordx2 v[236:237], v13, s[12:15], s31 offen offset:64
v_mfma_f32_16x16x32_bf16 v[44:47], a[164:167], v[120:123], v[44:47]
buffer_load_dwordx2 v[238:239], v13, s[12:15], s31 offen offset:96
v_mfma_f32_16x16x32_bf16 v[64:67], a[164:167], v[124:127], v[64:67]
buffer_load_dwordx2 v[240:241], v13, s[12:15], s31 offen offset:128
v_mfma_f32_16x16x32_bf16 v[84:87], a[164:167], v[128:131], v[84:87]
v_mfma_f32_16x16x32_bf16 v[104:107], a[164:167], v[132:135], v[104:107]
v_mfma_f32_16x16x32_bf16 v[48:51], a[168:171], v[120:123], v[48:51]
v_mfma_f32_16x16x32_bf16 v[68:71], a[168:171], v[124:127], v[68:71]
v_mfma_f32_16x16x32_bf16 v[88:91], a[168:171], v[128:131], v[88:91]
v_mfma_f32_16x16x32_bf16 v[108:111], a[168:171], v[132:135], v[108:111]
v_mfma_f32_16x16x32_bf16 v[52:55], a[172:175], v[120:123], v[52:55]
v_mfma_f32_16x16x32_bf16 v[72:75], a[172:175], v[124:127], v[72:75]
v_mfma_f32_16x16x32_bf16 v[92:95], a[172:175], v[128:131], v[92:95]
v_mfma_f32_16x16x32_bf16 v[112:115], a[172:175], v[132:135], v[112:115]
v_mfma_f32_16x16x32_bf16 v[56:59], a[176:179], v[120:123], v[56:59]
v_mfma_f32_16x16x32_bf16 v[76:79], a[176:179], v[124:127], v[76:79]
v_mfma_f32_16x16x32_bf16 v[96:99], a[176:179], v[128:131], v[96:99]
v_mfma_f32_16x16x32_bf16 v[116:119], a[176:179], v[132:135], v[116:119]
s_waitcnt vmcnt(14)
v_mfma_f32_16x16x32_bf16 v[40:43], a[180:183], v[136:139], v[40:43]
v_mfma_f32_16x16x32_bf16 v[60:63], a[180:183], v[140:143], v[60:63]
v_mov_b32 v7, 336
v_mul_u32_u24 v5, v7, v1
v_mfma_f32_16x16x32_bf16 v[80:83], a[180:183], v[144:147], v[80:83]
v_lshl_add_u32 v5, v2, 4, v5
v_mfma_f32_16x16x32_bf16 v[100:103], a[180:183], v[148:151], v[100:103]
s_add_u32 s56, s24, 1
s_and_b32 s56, s56, 3
s_mul_i32 s56, s56, 3
s_add_u32 s56, s56, 0
s_mul_i32 s56, s56, 5376
v_add_u32 v9, s56, v5
v_mfma_f32_16x16x32_bf16 v[44:47], a[184:187], v[136:139], v[44:47]
s_add_u32 s56, s24, 2
s_and_b32 s56, s56, 3
s_mul_i32 s56, s56, 3
s_add_u32 s56, s56, 1
s_mul_i32 s56, s56, 5376
v_add_u32 v10, s56, v5
v_mfma_f32_16x16x32_bf16 v[64:67], a[184:187], v[140:143], v[64:67]
s_add_u32 s56, s24, 3
s_and_b32 s56, s56, 3
s_mul_i32 s56, s56, 3
s_add_u32 s56, s56, 2
s_mul_i32 s56, s56, 5376
v_add_u32 v11, s56, v5
v_mfma_f32_16x16x32_bf16 v[84:87], a[184:187], v[144:147], v[84:87]
s_mul_i32 s56, s24, 16128
v_add_u32 v14, s56, v5
v_mfma_f32_16x16x32_bf16 v[104:107], a[184:187], v[148:151], v[104:107]
s_mul_i32 s57, s24, 7168
s_add_u32 s57, s57, 102400
v_lshl_add_u32 v3, v0, 4, s57
v_mfma_f32_16x16x32_bf16 v[48:51], a[188:191], v[136:139], v[48:51]
v_mfma_f32_16x16x32_bf16 v[68:71], a[188:191], v[140:143], v[68:71]
v_mfma_f32_16x16x32_bf16 v[88:91], a[188:191], v[144:147], v[88:91]
v_mfma_f32_16x16x32_bf16 v[108:111], a[188:191], v[148:151], v[108:111]
v_mfma_f32_16x16x32_bf16 v[52:55], a[192:195], v[136:139], v[52:55]
v_mfma_f32_16x16x32_bf16 v[72:75], a[192:195], v[140:143], v[72:75]
v_mfma_f32_16x16x32_bf16 v[92:95], a[192:195], v[144:147], v[92:95]
v_mfma_f32_16x16x32_bf16 v[112:115], a[192:195], v[148:151], v[112:115]
v_mfma_f32_16x16x32_bf16 v[56:59], a[196:199], v[136:139], v[56:59]
v_mfma_f32_16x16x32_bf16 v[76:79], a[196:199], v[140:143], v[76:79]
v_mfma_f32_16x16x32_bf16 v[96:99], a[196:199], v[144:147], v[96:99]
v_mfma_f32_16x16x32_bf16 v[116:119], a[196:199], v[148:151], v[116:119]
s_waitcnt vmcnt(10)
s_cmp_lg_u32 s92, 0
s_cbranch_scc1 K2_noepc
s_mov_b32 s56, 11534336
v_lshl_add_u32 v5, v0, 4, s56
global_load_dword v242, v5, s[86:87] offset:0 sc1
global_load_dword v243, v5, s[86:87] offset:1024 sc1
global_load_dword v244, v5, s[86:87] offset:2048 sc1
global_load_dword v245, v5, s[86:87] offset:3072 sc1
global_load_dword v246, v15, s[86:87] sc1
K2_noepc:
v_mfma_f32_16x16x32_bf16 v[40:43], a[200:203], v[152:155], v[40:43]
v_mfma_f32_16x16x32_bf16 v[60:63], a[200:203], v[156:159], v[60:63]
v_mfma_f32_16x16x32_bf16 v[80:83], a[200:203], v[160:163], v[80:83]
v_mfma_f32_16x16x32_bf16 v[100:103], a[200:203], v[164:167], v[100:103]
v_mfma_f32_16x16x32_bf16 v[44:47], a[204:207], v[152:155], v[44:47]
v_mfma_f32_16x16x32_bf16 v[64:67], a[204:207], v[156:159], v[64:67]
v_mfma_f32_16x16x32_bf16 v[84:87], a[204:207], v[160:163], v[84:87]
v_mfma_f32_16x16x32_bf16 v[104:107], a[204:207], v[164:167], v[104:107]
v_mfma_f32_16x16x32_bf16 v[48:51], a[208:211], v[152:155], v[48:51]
v_mfma_f32_16x16x32_bf16 v[68:71], a[208:211], v[156:159], v[68:71]
v_mfma_f32_16x16x32_bf16 v[88:91], a[208:211], v[160:163], v[88:91]
v_mfma_f32_16x16x32_bf16 v[108:111], a[208:211], v[164:167], v[108:111]
v_mfma_f32_16x16x32_bf16 v[52:55], a[212:215], v[152:155], v[52:55]
v_mfma_f32_16x16x32_bf16 v[72:75], a[212:215], v[156:159], v[72:75]
v_mfma_f32_16x16x32_bf16 v[92:95], a[212:215], v[160:163], v[92:95]
v_mfma_f32_16x16x32_bf16 v[112:115], a[212:215], v[164:167], v[112:115]
v_mfma_f32_16x16x32_bf16 v[56:59], a[216:219], v[152:155], v[56:59]
v_mfma_f32_16x16x32_bf16 v[76:79], a[216:219], v[156:159], v[76:79]
v_mfma_f32_16x16x32_bf16 v[96:99], a[216:219], v[160:163], v[96:99]
v_mfma_f32_16x16x32_bf16 v[116:119], a[216:219], v[164:167], v[116:119]
s_waitcnt vmcnt(5)
v_mfma_f32_16x16x32_bf16 v[60:63], a[220:223], v[172:175], v[60:63]
v_mfma_f32_16x16x32_bf16 v[64:67], a[224:227], v[172:175], v[64:67]
v_mfma_f32_16x16x32_bf16 v[68:71], a[228:231], v[172:175], v[68:71]
v_mfma_f32_16x16x32_bf16 v[72:75], a[232:235], v[172:175], v[72:75]
v_mfma_f32_16x16x32_bf16 v[76:79], a[236:239], v[172:175], v[76:79]
v_mfma_f32_16x16x32_bf16 v[80:83], a[220:223], v[176:179], v[80:83]
v_mfma_f32_16x16x32_bf16 v[84:87], a[224:227], v[176:179], v[84:87]
v_mfma_f32_16x16x32_bf16 v[88:91], a[228:231], v[176:179], v[88:91]
v_mfma_f32_16x16x32_bf16 v[92:95], a[232:235], v[176:179], v[92:95]
v_mfma_f32_16x16x32_bf16 v[96:99], a[236:239], v[176:179], v[96:99]
v_mfma_f32_16x16x32_bf16 v[100:103], a[220:223], v[180:183], v[100:103]
ds_write_b128 v9, v[60:63] offset:0
v_mfma_f32_16x16x32_bf16 v[104:107], a[224:227], v[180:183], v[104:107]
ds_write_b128 v9, v[64:67] offset:64
v_mfma_f32_16x16x32_bf16 v[108:111], a[228:231], v[180:183], v[108:111]
ds_write_b128 v9, v[68:71] offset:128
v_mfma_f32_16x16x32_bf16 v[112:115], a[232:235], v[180:183], v[112:115]
ds_write_b128 v9, v[72:75] offset:192
v_mfma_f32_16x16x32_bf16 v[116:119], a[236:239], v[180:183], v[116:119]
ds_write_b128 v9, v[76:79] offset:256
v_mfma_f32_16x16x32_bf16 v[40:43], a[220:223], v[168:171], v[40:43]
ds_write_b128 v10, v[80:83] offset:0
v_mfma_f32_16x16x32_bf16 v[44:47], a[224:227], v[168:171], v[44:47]
ds_write_b128 v10, v[84:87] offset:64
v_mfma_f32_16x16x32_bf16 v[48:51], a[228:231], v[168:171], v[48:51]
ds_write_b128 v10, v[88:91] offset:128
v_mfma_f32_16x16x32_bf16 v[52:55], a[232:235], v[168:171], v[52:55]
ds_write_b128 v10, v[92:95] offset:192
v_mfma_f32_16x16x32_bf16 v[56:59], a[236:239], v[168:171], v[56:59]
ds_write_b128 v10, v[96:99] offset:256
ds_write_b128 v11, v[100:103] offset:0
ds_write_b128 v11, v[104:107] offset:64
ds_write_b128 v11, v[108:111] offset:128
ds_write_b128 v11, v[112:115] offset:192
ds_write_b128 v11, v[116:119] offset:256
s_waitcnt lgkmcnt(0)
s_barrier
ds_read_b128 v[120:123], v14 offset:0
ds_read_b128 v[124:127], v14 offset:64
ds_read_b128 v[128:131], v14 offset:128
ds_read_b128 v[132:135], v14 offset:192
ds_read_b128 v[136:139], v14 offset:256
ds_read_b128 v[140:143], v14 offset:5376
ds_read_b128 v[144:147], v14 offset:5440
ds_read_b128 v[148:151], v14 offset:5504
ds_read_b128 v[152:155], v14 offset:5568
ds_read_b128 v[156:159], v14 offset:5632
ds_read_b128 v[160:163], v14 offset:10752
ds_read_b128 v[164:167], v14 offset:10816
ds_read_b128 v[168:171], v14 offset:10880
ds_read_b128 v[172:175], v14 offset:10944
ds_read_b128 v[176:179], v14 offset:11008
v_mov_b32 v6, 0xbf317218
v_mov_b32 v7, 0xbf317218
s_waitcnt lgkmcnt(5)
v_pk_add_f32 v[40:41], v[40:41], v[120:121]
v_pk_add_f32 v[42:43], v[42:43], v[122:123]
v_pk_add_f32 v[44:45], v[44:45], v[124:125]
v_pk_add_f32 v[46:47], v[46:47], v[126:127]
v_pk_add_f32 v[48:49], v[48:49], v[128:129]
v_pk_add_f32 v[50:51], v[50:51], v[130:131]
v_pk_add_f32 v[52:53], v[52:53], v[132:133]
v_pk_add_f32 v[54:55], v[54:55], v[134:135]
v_pk_add_f32 v[56:57], v[56:57], v[136:137]
v_pk_add_f32 v[58:59], v[58:59], v[138:139]
v_pk_add_f32 v[40:41], v[40:41], v[140:141]
v_pk_add_f32 v[42:43], v[42:43], v[142:143]
v_pk_add_f32 v[44:45], v[44:45], v[144:145]
v_pk_add_f32 v[46:47], v[46:47], v[146:147]
v_pk_add_f32 v[48:49], v[48:49], v[148:149]
v_pk_add_f32 v[50:51], v[50:51], v[150:151]
v_pk_add_f32 v[52:53], v[52:53], v[152:153]
v_pk_add_f32 v[54:55], v[54:55], v[154:155]
v_pk_add_f32 v[56:57], v[56:57], v[156:157]
v_pk_add_f32 v[58:59], v[58:59], v[158:159]
s_waitcnt lgkmcnt(0)
v_pk_add_f32 v[40:41], v[40:41], v[160:161]
v_pk_add_f32 v[42:43], v[42:43], v[162:163]
v_pk_add_f32 v[44:45], v[44:45], v[164:165]
v_pk_add_f32 v[46:47], v[46:47], v[166:167]
v_pk_add_f32 v[48:49], v[48:49], v[168:169]
v_pk_add_f32 v[50:51], v[50:51], v[170:171]
v_pk_add_f32 v[52:53], v[52:53], v[172:173]
v_pk_add_f32 v[54:55], v[54:55], v[174:175]
v_pk_add_f32 v[56:57], v[56:57], v[176:177]
v_pk_add_f32 v[58:59], v[58:59], v[178:179]
v_exp_f32 v60, v40
v_exp_f32 v61, v41
v_exp_f32 v62, v42
v_exp_f32 v63, v43
v_exp_f32 v64, v44
v_exp_f32 v65, v45
v_exp_f32 v66, v46
v_exp_f32 v67, v47
v_exp_f32 v68, v48
v_exp_f32 v69, v49
v_exp_f32 v70, v50
v_exp_f32 v71, v51
v_exp_f32 v72, v52
v_exp_f32 v73, v53
v_exp_f32 v74, v54
v_exp_f32 v75, v55
v_exp_f32 v76, v56
v_exp_f32 v77, v57
v_exp_f32 v78, v58
v_exp_f32 v79, v59
v_pk_add_f32 v[60:61], v[60:61], 1.0 op_sel_hi:[1,0]
v_pk_add_f32 v[62:63], v[62:63], 1.0 op_sel_hi:[1,0]
v_pk_mul_f32 v[40:41], v[40:41], v[6:7]
v_pk_mul_f32 v[42:43], v[42:43], v[6:7]
v_pk_add_f32 v[64:65], v[64:65], 1.0 op_sel_hi:[1,0]
v_pk_add_f32 v[66:67], v[66:67], 1.0 op_sel_hi:[1,0]
v_pk_mul_f32 v[44:45], v[44:45], v[6:7]
v_pk_mul_f32 v[46:47], v[46:47], v[6:7]
v_pk_add_f32 v[68:69], v[68:69], 1.0 op_sel_hi:[1,0]
v_pk_add_f32 v[70:71], v[70:71], 1.0 op_sel_hi:[1,0]
v_pk_mul_f32 v[48:49], v[48:49], v[6:7]
v_pk_mul_f32 v[50:51], v[50:51], v[6:7]
v_pk_add_f32 v[72:73], v[72:73], 1.0 op_sel_hi:[1,0]
v_pk_add_f32 v[74:75], v[74:75], 1.0 op_sel_hi:[1,0]
v_pk_mul_f32 v[52:53], v[52:53], v[6:7]
v_pk_mul_f32 v[54:55], v[54:55], v[6:7]
v_pk_add_f32 v[76:77], v[76:77], 1.0 op_sel_hi:[1,0]
v_pk_add_f32 v[78:79], v[78:79], 1.0 op_sel_hi:[1,0]
v_pk_mul_f32 v[56:57], v[56:57], v[6:7]
v_pk_mul_f32 v[58:59], v[58:59], v[6:7]
v_rcp_f32 v60, v60
v_rcp_f32 v61, v61
v_rcp_f32 v62, v62
v_rcp_f32 v63, v63
v_rcp_f32 v64, v64
v_rcp_f32 v65, v65
v_rcp_f32 v66, v66
v_rcp_f32 v67, v67
v_rcp_f32 v68, v68
v_rcp_f32 v69, v69
v_rcp_f32 v70, v70
v_rcp_f32 v71, v71
v_rcp_f32 v72, v72
v_rcp_f32 v73, v73
v_rcp_f32 v74, v74
v_rcp_f32 v75, v75
v_rcp_f32 v76, v76
v_rcp_f32 v77, v77
v_rcp_f32 v78, v78
v_rcp_f32 v79, v79
s_nop 0
v_pk_mul_f32 v[40:41], v[40:41], v[60:61]
v_pk_mul_f32 v[42:43], v[42:43], v[62:63]
v_pk_mul_f32 v[44:45], v[44:45], v[64:65]
v_pk_mul_f32 v[46:47], v[46:47], v[66:67]
v_pk_mul_f32 v[48:49], v[48:49], v[68:69]
v_pk_mul_f32 v[50:51], v[50:51], v[70:71]
v_pk_mul_f32 v[52:53], v[52:53], v[72:73]
v_pk_mul_f32 v[54:55], v[54:55], v[74:75]
v_pk_mul_f32 v[56:57], v[56:57], v[76:77]
v_pk_mul_f32 v[58:59], v[58:59], v[78:79]
s_mov_b32 s62, 0
K2_usp1:
global_load_dword v253, v15, s[86:87] sc1
s_waitcnt vmcnt(0)
v_cmp_ne_u32 vcc, s65, v253
s_add_u32 s62, s62, 1
s_nop 1
s_cbranch_vccz K2_usp2
s_cmp_lt_u32 s62, 200000
s_cbranch_scc1 K2_usp1
K2_usp2:
buffer_load_dwordx4 v[16:19], v16, s[8:11], s32 offen sc1
buffer_load_dwordx4 v[20:23], v20, s[8:11], s32 offen sc1
buffer_load_dwordx4 v[24:27], v24, s[8:11], s32 offen sc1
buffer_load_dwordx4 v[28:31], v28, s[8:11], s32 offen sc1
buffer_load_dwordx4 v[32:35], v32, s[8:11], s32 offen sc1
buffer_load_dwordx4 v[36:39], v36, s[8:11], s32 offen sc1
buffer_load_dwordx4 v[248:251], v248, s[8:11], s32 offen sc1
s_waitcnt vmcnt(0)
s_branch K2_join
F_codeend:
.section .rodata,"a"
.p2align 6
.amdhsa_kernel recurrent_scan__spectral_fnet__dense_activation_silu__prompt_kernel
  .amdhsa_next_free_vgpr 512
  .amdhsa_next_free_sgpr 102
  .amdhsa_accum_offset 256
  .amdhsa_group_segment_fixed_size 0
  .amdhsa_kernarg_size 88
  .amdhsa_user_sgpr_count 2
  .amdhsa_user_sgpr_kernarg_segment_ptr 1
  .amdhsa_system_sgpr_workgroup_id_x 1
.end_amdhsa_kernel
```
